```python
import torch

def _softmax(x, axis=-1):
    return torch.softmax(x, dim=axis)
def _gelu(x):
    return torch.nn.functional.gelu(x, approximate="tanh")
def _silu(x):
    return torch.nn.functional.silu(x)
def _sigmoid(x):
    return torch.sigmoid(x)
def _layernorm(x, axis=-1, eps=1e-5):
    m = x.mean(dim=axis, keepdim=True)
    v = x.var(dim=axis, keepdim=True, unbiased=False)
    return (x - m) / torch.sqrt(v + eps)
def _scatter_add(tgt, idx, src, axis=0):
    return tgt.clone().index_add_(axis, idx, src)
def _segment_sum(src, seg, n):
    out = torch.zeros((n,) + src.shape[1:], dtype=src.dtype)
    return out.index_add_(0, seg, src)
def _pad(x, pw):
    flat = tuple(v for pair in reversed(pw) for v in pair)
    return torch.nn.functional.pad(x, flat)

kernel_name = 'sequential_preLN__mha_block_cached__glu_gated_geglu__decode'

def setup_inputs():

    _w = (lambda a: (lambda t: t.to(torch.bfloat16) if t.is_floating_point() else t)(torch.as_tensor(a)))
    def _A_setup():
        B, Sq, D = 4, 1, 448
        H, Sk, Dh = 16, 4096, 256
        return {
            "x": _w((lambda *s: torch.randn(*s, dtype=torch.bfloat16) * 0.05)(B, Sq, D)),
            "k_cache": _w((lambda *s: torch.randn(*s, dtype=torch.bfloat16) * 1.6)(B, H, Sk, Dh)),
            "v_cache": _w((lambda *s: torch.randn(*s, dtype=torch.bfloat16) * 0.8)(B, H, Sk, Dh)),
            "wq": _w((lambda *s: torch.randn(*s, dtype=torch.bfloat16) * 1.6)(D, H * Dh) * (D ** -0.5)),
            "wo": _w((lambda *s: torch.randn(*s, dtype=torch.bfloat16) * 0.8)(H * Dh, D) * ((H * Dh) ** -0.5)),
        }
    _A_in = _A_setup()

    def _B_setup():
        B, S, Dm, Df = 4, 1, 448, 1792
        return {
            "x": _w((lambda *s: torch.randn(*s, dtype=torch.bfloat16) * 0.05)(B, S, Dm)),
            "w_gate": _w((lambda *s: torch.randn(*s, dtype=torch.bfloat16) * 0.8)(Dm, Df) * (Dm ** -0.5)),
            "w_up": _w((lambda *s: torch.randn(*s, dtype=torch.bfloat16) * 0.8)(Dm, Df) * (Dm ** -0.5)),
            "w_down": _w((lambda *s: torch.randn(*s, dtype=torch.bfloat16) * 0.8)(Df, Dm) * (Df ** -0.5)),
        }
    _B_in = _B_setup()

    return {
        "A_x": _A_in["x"],
        "A_k_cache": _A_in["k_cache"],
        "A_v_cache": _A_in["v_cache"],
        "A_wq": _A_in["wq"],
        "A_wo": _A_in["wo"],
        "B_x": _B_in["x"],
        "B_w_gate": _B_in["w_gate"],
        "B_w_up": _B_in["w_up"],
        "B_w_down": _B_in["w_down"],
    }

def reference(A_x, A_k_cache, A_v_cache, A_wq, A_wo, B_x, B_w_gate, B_w_up, B_w_down):
    def _A_ref(x, k_cache, v_cache, wq, wo):
        B, Sq, D = x.shape
        H, Dh = 16, 256
        q = (lambda x, *d: x.permute(*d))((x @ wq).reshape(B, Sq, H, Dh), 0, 2, 1, 3)
        scores = torch.einsum("bhqd,bhkd->bhqk", q, k_cache) * (Dh ** -0.5)
        p = _softmax(scores, axis=-1)
        o = torch.einsum("bhqk,bhkd->bhqd", p, v_cache)
        return (lambda x, *d: x.permute(*d))(o, 0, 2, 1, 3).reshape(B, Sq, H * Dh) @ wo

    def _B_ref(x, w_gate, w_up, w_down):
        g = torch.einsum("bsd,df->bsf", x, w_gate)
        u = torch.einsum("bsd,df->bsf", x, w_up)
        h = _gelu(g) * u
        return torch.einsum("bsf,fd->bsd", h, w_down)

    x = A_x
    h = x + _A_ref(_layernorm(x, axis=-1), A_k_cache, A_v_cache, A_wq, A_wo)
    h2 = h + _B_ref(_layernorm(h, axis=-1), B_w_gate, B_w_up, B_w_down)
    return h2
```

```asm
; @launch grid=(256,1,1) block=(512,1,1) lds=114688
.amdgcn_target "amdgcn-amd-amdhsa--gfx950"
.text
.globl sequential_preLN__mha_block_cached__glu_gated_geglu__decode_kernel
.p2align 8
.type sequential_preLN__mha_block_cached__glu_gated_geglu__decode_kernel,@function
sequential_preLN__mha_block_cached__glu_gated_geglu__decode_kernel:
    s_cmp_ge_u32 s2, 256
    s_cbranch_scc1 L_end
    s_load_dwordx16 s[4:19], s[0:1], 0
    s_load_dwordx8 s[20:27], s[0:1], 64
    s_getpc_b64 s[74:75]
L_pc0:
    s_lshl_b32 s76, s2, 8
    s_and_b32 s76, s76, 0x7800
    v_lshl_add_u32 v5, v0, 2, s76
    v_min_u32 v5, L_codeend-L_pc0, v5
    global_load_dword v16, v5, s[74:75]
    v_lshrrev_b32 v5, 6, v0
    v_and_b32 v1, 63, v0
    v_readfirstlane_b32 s68, v5
    v_lshlrev_b32 v5, 12, v5
    v_and_b32 v6, 12, v0
    v_lshl_add_u32 v2, v6, 7, v5
    v_and_b32 v6, 48, v0
    v_lshl_add_u32 v2, v6, 2, v2
    v_lshl_add_u32 v3, v6, 5, v5
    v_and_b32 v6, 3, v0
    v_lshl_add_u32 v2, v6, 4, v2
    v_and_b32 v6, 15, v0
    v_lshl_add_u32 v3, v6, 4, v3
    s_lshr_b32 s69, s2, 6
    s_and_b32 s70, s2, 7
    s_lshl_b32 s70, s70, 1
    s_bfe_u32 s74, s2, 0x10003
    s_add_u32 s70, s70, s74
    s_bfe_u32 s69, s2, 0x20004
    s_lshr_b32 s74, s2, 6
    s_lshl_b32 s71, s69, 4
    s_add_u32 s71, s71, s70
    s_lshl_b32 s71, s71, 2
    s_add_u32 s71, s71, s74
    s_lshl_b32 s74, s71, 19
    s_mul_i32 s75, s69, 896
    s_lshl_b32 s76, s70, 9
    s_mov_b32 s82, s69
    s_waitcnt lgkmcnt(0)
    s_add_u32 s28, s6, s74
    s_addc_u32 s29, s7, 0
    s_mov_b32 s30, 0x80000
    s_mov_b32 s31, 0x20000
    s_cmp_eq_u32 s68, 7
    s_cbranch_scc1 L_w7pro
    s_add_u32 s44, s4, s75
    s_addc_u32 s45, s5, 0
    s_mov_b32 s46, 896
    s_mov_b32 s47, 0x20000
    v_lshlrev_b32 v5, 4, v1
    buffer_load_dwordx4 v[48:51], v5, s[44:47], 0 offen
    s_lshr_b32 s77, s2, 4
    v_add_u32 v8, s77, v6
    v_and_b32 v8, 15, v8
    v_and_b32 v5, 0x1c0, v0
    v_lshl_add_u32 v5, v8, 2, v5
    v_bfe_u32 v7, v0, 4, 2
    v_add_lshl_u32 v5, v5, v7, 1
    buffer_load_ushort v52, v5, s[44:47], 0 offen
    s_add_u32 s36, s10, s76
    s_addc_u32 s37, s11, 0
    s_mov_b32 s38, 0
    s_mov_b32 s39, 0x20000
    s_sub_u32 s38, 3670016, s76
    v_and_b32 v5, 0x1c0, v0
    v_add_u32 v5, v5, v7
    v_lshlrev_b32 v5, 13, v5
    v_lshl_add_u32 v5, v6, 4, v5
    s_lshl_b32 s73, s77, 15
    buffer_load_dwordx4 v[128:131], v5, s[36:39], s73 offen offset:0
    buffer_load_dwordx4 v[132:135], v5, s[36:39], s73 offen offset:256
    s_add_u32 s73, s73, 0x8000
    s_and_b32 s73, s73, 0x7ffff
    buffer_load_dwordx4 v[136:139], v5, s[36:39], s73 offen offset:0
    buffer_load_dwordx4 v[140:143], v5, s[36:39], s73 offen offset:256
    s_cmp_lt_u32 s82, 1
    s_cbranch_scc1 L_kpre1
    s_mov_b32 s72, 0
    buffer_load_dwordx4 v[64:67], v2, s[28:31], s72 offen offset:0 nt
    buffer_load_dwordx4 v[68:71], v2, s[28:31], s72 offen offset:256 nt
    buffer_load_dwordx4 v[72:75], v2, s[28:31], s72 offen offset:2048 nt
    buffer_load_dwordx4 v[76:79], v2, s[28:31], s72 offen offset:2304 nt
    s_mov_b32 s72, 32768
    buffer_load_dwordx4 v[80:83], v2, s[28:31], s72 offen offset:0 nt
    buffer_load_dwordx4 v[84:87], v2, s[28:31], s72 offen offset:256 nt
    buffer_load_dwordx4 v[88:91], v2, s[28:31], s72 offen offset:2048 nt
    buffer_load_dwordx4 v[92:95], v2, s[28:31], s72 offen offset:2304 nt
    s_cmp_lt_u32 s82, 2
    s_cbranch_scc1 L_kpre1
    s_mov_b32 s72, 65536
    buffer_load_dwordx4 v[96:99], v2, s[28:31], s72 offen offset:0 nt
    buffer_load_dwordx4 v[100:103], v2, s[28:31], s72 offen offset:256 nt
    buffer_load_dwordx4 v[104:107], v2, s[28:31], s72 offen offset:2048 nt
    buffer_load_dwordx4 v[108:111], v2, s[28:31], s72 offen offset:2304 nt
    s_mov_b32 s72, 98304
    buffer_load_dwordx4 v[112:115], v2, s[28:31], s72 offen offset:0 nt
    buffer_load_dwordx4 v[116:119], v2, s[28:31], s72 offen offset:256 nt
    buffer_load_dwordx4 v[120:123], v2, s[28:31], s72 offen offset:2048 nt
    buffer_load_dwordx4 v[124:127], v2, s[28:31], s72 offen offset:2304 nt
    s_cmp_lt_u32 s82, 3
    s_cbranch_scc1 L_kpre1
    s_mov_b32 s72, 131072
    buffer_load_dwordx4 v[176:179], v2, s[28:31], s72 offen offset:0 nt
    buffer_load_dwordx4 v[180:183], v2, s[28:31], s72 offen offset:256 nt
    buffer_load_dwordx4 v[184:187], v2, s[28:31], s72 offen offset:2048 nt
    buffer_load_dwordx4 v[188:191], v2, s[28:31], s72 offen offset:2304 nt
    s_mov_b32 s72, 163840
    buffer_load_dwordx4 v[192:195], v2, s[28:31], s72 offen offset:0 nt
    buffer_load_dwordx4 v[196:199], v2, s[28:31], s72 offen offset:256 nt
    buffer_load_dwordx4 v[200:203], v2, s[28:31], s72 offen offset:2048 nt
    buffer_load_dwordx4 v[204:207], v2, s[28:31], s72 offen offset:2304 nt
L_kpre1:
    s_barrier
    s_add_u32 s73, s73, 0x8000
    s_and_b32 s73, s73, 0x7ffff
    buffer_load_dwordx4 v[144:147], v5, s[36:39], s73 offen offset:0
    buffer_load_dwordx4 v[148:151], v5, s[36:39], s73 offen offset:256
    s_add_u32 s73, s73, 0x8000
    s_and_b32 s73, s73, 0x7ffff
    buffer_load_dwordx4 v[152:155], v5, s[36:39], s73 offen offset:0
    buffer_load_dwordx4 v[156:159], v5, s[36:39], s73 offen offset:256
    s_add_u32 s73, s73, 0x8000
    s_and_b32 s73, s73, 0x7ffff
    buffer_load_dwordx4 v[160:163], v5, s[36:39], s73 offen offset:0
    buffer_load_dwordx4 v[164:167], v5, s[36:39], s73 offen offset:256
    s_add_u32 s73, s73, 0x8000
    s_and_b32 s73, s73, 0x7ffff
    buffer_load_dwordx4 v[168:171], v5, s[36:39], s73 offen offset:0
    buffer_load_dwordx4 v[172:175], v5, s[36:39], s73 offen offset:256
    s_add_u32 s32, s8, s74
    s_addc_u32 s33, s9, 0
    s_mov_b32 s34, 0x80000
    s_mov_b32 s35, 0x20000
    v_and_b32 v8, 1, v0
    v_lshlrev_b32 v8, 4, v8
    v_mov_b32 v9, 0xffff
    v_lshlrev_b32 v8, v8, v9
    v_bfe_u32 v9, v0, 1, 3
    v_cmp_eq_u32 vcc, 0, v9
    s_nop 1
    v_cndmask_b32 v12, 0, v8, vcc
    v_cmp_eq_u32 vcc, 1, v9
    s_nop 1
    v_cndmask_b32 v13, 0, v8, vcc
    v_cmp_eq_u32 vcc, 2, v9
    s_nop 1
    v_cndmask_b32 v14, 0, v8, vcc
    v_cmp_eq_u32 vcc, 3, v9
    s_nop 1
    v_cndmask_b32 v15, 0, v8, vcc
    s_mul_i32 s74, s70, 229376
    s_add_u32 s40, s12, s74
    s_addc_u32 s41, s13, 0
    s_mov_b32 s42, 229376
    s_mov_b32 s43, 0x20000
    s_cmp_eq_u32 s68, 7
    s_cselect_b32 s42, 0, s42
    v_and_b32 v8, 8, v0
    v_lshlrev_b32 v8, 2, v8
    v_and_b32 v9, 48, v0
    v_lshrrev_b32 v9, 1, v9
    v_add_u32 v8, v8, v9
    v_mul_u32_u24 v4, 896, v8
    v_and_b32 v8, 7, v0
    v_lshl_add_u32 v4, v8, 4, v4
    v_and_b32 v8, 0x1c0, v0
    v_lshl_add_u32 v4, v8, 1, v4
    s_mov_b32 s78, 0x3db8aa3b
    s_mov_b32 s80, 0x05040100
    s_mov_b32 s81, 0x07060302
    s_mov_b32 s48, s26
    s_mov_b32 s49, s27
    s_mov_b32 s50, 0x110000
    s_mov_b32 s51, 0x20000
    s_and_b32 s75, s2, 7
    s_lshr_b32 s76, s2, 4
    s_lshl_b32 s76, s76, 3
    s_add_u32 s75, s75, s76
    s_bfe_u32 s76, s2, 0x10003
    s_lshl_b32 s79, s75, 1
    s_add_u32 s79, s79, s76
    s_cmp_lt_u32 s75, 28
    s_cselect_b32 s79, s79, -1
    s_sub_u32 s83, s2, 64
    s_cmp_eq_u32 s82, 0
    s_cbranch_scc0 L_xw0
    s_waitcnt vmcnt(12)
    s_branch L_xwx
L_xw0:
    s_cmp_eq_u32 s82, 1
    s_cbranch_scc0 L_xw1
    s_waitcnt vmcnt(20)
    s_branch L_xwx
L_xw1:
    s_cmp_eq_u32 s82, 2
    s_cbranch_scc0 L_xw2
    s_waitcnt vmcnt(28)
    s_branch L_xwx
L_xw2:
    s_waitcnt vmcnt(36)
L_xwx:
    v_lshlrev_b32 v53, 16, v48
    v_and_b32 v54, 0xffff0000, v48
    v_lshlrev_b32 v55, 16, v49
    v_and_b32 v56, 0xffff0000, v49
    v_lshlrev_b32 v57, 16, v50
    v_and_b32 v58, 0xffff0000, v50
    v_lshlrev_b32 v59, 16, v51
    v_and_b32 v60, 0xffff0000, v51
    v_add_f32 v61, v53, v54
    v_add_f32 v62, v55, v56
    v_add_f32 v61, v61, v57
    v_add_f32 v62, v62, v58
    v_add_f32 v61, v61, v59
    v_add_f32 v62, v62, v60
    v_add_f32 v61, v61, v62
    v_cmp_gt_u32 vcc, 56, v1
    s_nop 0
    v_add_f32_dpp v61, v61, v61 row_ror:1 row_mask:0xf bank_mask:0xf
    s_nop 1
    v_add_f32_dpp v61, v61, v61 row_ror:2 row_mask:0xf bank_mask:0xf
    s_nop 1
    v_add_f32_dpp v61, v61, v61 row_ror:4 row_mask:0xf bank_mask:0xf
    s_nop 1
    v_add_f32_dpp v61, v61, v61 row_ror:8 row_mask:0xf bank_mask:0xf
    v_mov_b32 v62, v61
    s_nop 1
    v_permlane16_swap_b32 v61, v62
    v_add_f32 v61, v61, v62
    v_mov_b32 v62, v61
    s_nop 1
    v_permlane32_swap_b32 v61, v62
    v_add_f32 v61, v61, v62
    v_mul_f32 v61, 0x3b124925, v61
    v_cndmask_b32 v62, 0, v61, vcc
    v_sub_f32 v53, v53, v62
    v_sub_f32 v54, v54, v62
    v_sub_f32 v55, v55, v62
    v_sub_f32 v56, v56, v62
    v_sub_f32 v57, v57, v62
    v_sub_f32 v58, v58, v62
    v_sub_f32 v59, v59, v62
    v_sub_f32 v60, v60, v62
    v_mul_f32 v63, v53, v53
    v_mul_f32 v62, v54, v54
    v_fmac_f32 v63, v55, v55
    v_fmac_f32 v62, v56, v56
    v_fmac_f32 v63, v57, v57
    v_fmac_f32 v62, v58, v58
    v_fmac_f32 v63, v59, v59
    v_fmac_f32 v62, v60, v60
    v_add_f32 v63, v63, v62
    s_nop 1
    v_add_f32_dpp v63, v63, v63 row_ror:1 row_mask:0xf bank_mask:0xf
    s_nop 1
    v_add_f32_dpp v63, v63, v63 row_ror:2 row_mask:0xf bank_mask:0xf
    s_nop 1
    v_add_f32_dpp v63, v63, v63 row_ror:4 row_mask:0xf bank_mask:0xf
    s_nop 1
    v_add_f32_dpp v63, v63, v63 row_ror:8 row_mask:0xf bank_mask:0xf
    v_mov_b32 v62, v63
    s_nop 1
    v_permlane16_swap_b32 v63, v62
    v_add_f32 v63, v63, v62
    v_mov_b32 v62, v63
    s_nop 1
    v_permlane32_swap_b32 v63, v62
    v_add_f32 v63, v63, v62
    v_mul_f32 v63, 0x3b124925, v63
    v_cvt_pk_bf16_f32 v62, v61, v63
    v_lshlrev_b32 v61, 16, v62
    v_and_b32 v63, 0xffff0000, v62
    v_add_f32 v63, 0x3727c5ac, v63
    v_cvt_pk_bf16_f32 v63, v63, v63
    v_and_b32 v63, 0xffff0000, v63
    v_sqrt_f32 v63, v63
    s_nop 0
    v_cvt_pk_bf16_f32 v63, v63, v63
    v_and_b32 v63, 0xffff0000, v63
    v_rcp_f32 v63, v63
    v_lshlrev_b32 v52, 16, v52
    v_sub_f32 v52, v52, v61
    v_cvt_pk_bf16_f32 v52, v52, v52
    v_and_b32 v52, 0xffff0000, v52
    v_mul_f32 v52, v52, v63
    v_cvt_pk_bf16_f32 v52, v52, v52
    s_nop 1
    v_and_b32_dpp v32, v52, v12 row_newbcast:0 row_mask:0xf bank_mask:0xf
    v_and_b32_dpp v33, v52, v13 row_newbcast:0 row_mask:0xf bank_mask:0xf
    v_and_b32_dpp v34, v52, v14 row_newbcast:0 row_mask:0xf bank_mask:0xf
    v_and_b32_dpp v35, v52, v15 row_newbcast:0 row_mask:0xf bank_mask:0xf
    s_waitcnt vmcnt(11)
    s_nop 0
    v_mfma_f32_16x16x32_bf16 v[40:43], v[32:35], v[128:131], 0
    s_waitcnt vmcnt(10)
    v_mfma_f32_16x16x32_bf16 v[44:47], v[32:35], v[132:135], 0
    v_and_b32_dpp v36, v52, v12 row_newbcast:1 row_mask:0xf bank_mask:0xf
    v_and_b32_dpp v37, v52, v13 row_newbcast:1 row_mask:0xf bank_mask:0xf
    v_and_b32_dpp v38, v52, v14 row_newbcast:1 row_mask:0xf bank_mask:0xf
    v_and_b32_dpp v39, v52, v15 row_newbcast:1 row_mask:0xf bank_mask:0xf
    s_waitcnt vmcnt(9)
    s_nop 0
    v_mfma_f32_16x16x32_bf16 v[40:43], v[36:39], v[136:139], v[40:43]
    s_waitcnt vmcnt(8)
    v_mfma_f32_16x16x32_bf16 v[44:47], v[36:39], v[140:143], v[44:47]
    v_and_b32_dpp v32, v52, v12 row_newbcast:2 row_mask:0xf bank_mask:0xf
    v_and_b32_dpp v33, v52, v13 row_newbcast:2 row_mask:0xf bank_mask:0xf
    v_and_b32_dpp v34, v52, v14 row_newbcast:2 row_mask:0xf bank_mask:0xf
    v_and_b32_dpp v35, v52, v15 row_newbcast:2 row_mask:0xf bank_mask:0xf
    s_waitcnt vmcnt(7)
    s_nop 0
    v_mfma_f32_16x16x32_bf16 v[40:43], v[32:35], v[144:147], v[40:43]
    s_add_u32 s73, s73, 0x8000
    s_and_b32 s73, s73, 0x7ffff
    buffer_load_dwordx4 v[144:147], v5, s[36:39], s73 offen offset:0
    s_waitcnt vmcnt(7)
    v_mfma_f32_16x16x32_bf16 v[44:47], v[32:35], v[148:151], v[44:47]
    buffer_load_dwordx4 v[148:151], v5, s[36:39], s73 offen offset:256
    v_and_b32_dpp v36, v52, v12 row_newbcast:3 row_mask:0xf bank_mask:0xf
    v_and_b32_dpp v37, v52, v13 row_newbcast:3 row_mask:0xf bank_mask:0xf
    v_and_b32_dpp v38, v52, v14 row_newbcast:3 row_mask:0xf bank_mask:0xf
    v_and_b32_dpp v39, v52, v15 row_newbcast:3 row_mask:0xf bank_mask:0xf
    s_waitcnt vmcnt(7)
    s_nop 0
    v_mfma_f32_16x16x32_bf16 v[40:43], v[36:39], v[152:155], v[40:43]
    s_add_u32 s73, s73, 0x8000
    s_and_b32 s73, s73, 0x7ffff
    buffer_load_dwordx4 v[152:155], v5, s[36:39], s73 offen offset:0
    s_waitcnt vmcnt(7)
    v_mfma_f32_16x16x32_bf16 v[44:47], v[36:39], v[156:159], v[44:47]
    buffer_load_dwordx4 v[156:159], v5, s[36:39], s73 offen offset:256
    v_and_b32_dpp v32, v52, v12 row_newbcast:4 row_mask:0xf bank_mask:0xf
    v_and_b32_dpp v33, v52, v13 row_newbcast:4 row_mask:0xf bank_mask:0xf
    v_and_b32_dpp v34, v52, v14 row_newbcast:4 row_mask:0xf bank_mask:0xf
    v_and_b32_dpp v35, v52, v15 row_newbcast:4 row_mask:0xf bank_mask:0xf
    s_waitcnt vmcnt(7)
    s_nop 0
    v_mfma_f32_16x16x32_bf16 v[40:43], v[32:35], v[160:163], v[40:43]
    s_add_u32 s73, s73, 0x8000
    s_and_b32 s73, s73, 0x7ffff
    buffer_load_dwordx4 v[160:163], v5, s[36:39], s73 offen offset:0
    s_waitcnt vmcnt(7)
    v_mfma_f32_16x16x32_bf16 v[44:47], v[32:35], v[164:167], v[44:47]
    buffer_load_dwordx4 v[164:167], v5, s[36:39], s73 offen offset:256
    v_and_b32_dpp v36, v52, v12 row_newbcast:5 row_mask:0xf bank_mask:0xf
    v_and_b32_dpp v37, v52, v13 row_newbcast:5 row_mask:0xf bank_mask:0xf
    v_and_b32_dpp v38, v52, v14 row_newbcast:5 row_mask:0xf bank_mask:0xf
    v_and_b32_dpp v39, v52, v15 row_newbcast:5 row_mask:0xf bank_mask:0xf
    s_waitcnt vmcnt(7)
    s_nop 0
    v_mfma_f32_16x16x32_bf16 v[40:43], v[36:39], v[168:171], v[40:43]
    s_add_u32 s73, s73, 0x8000
    s_and_b32 s73, s73, 0x7ffff
    buffer_load_dwordx4 v[168:171], v5, s[36:39], s73 offen offset:0
    s_waitcnt vmcnt(7)
    v_mfma_f32_16x16x32_bf16 v[44:47], v[36:39], v[172:175], v[44:47]
    buffer_load_dwordx4 v[172:175], v5, s[36:39], s73 offen offset:256
    v_and_b32_dpp v32, v52, v12 row_newbcast:6 row_mask:0xf bank_mask:0xf
    v_and_b32_dpp v33, v52, v13 row_newbcast:6 row_mask:0xf bank_mask:0xf
    v_and_b32_dpp v34, v52, v14 row_newbcast:6 row_mask:0xf bank_mask:0xf
    v_and_b32_dpp v35, v52, v15 row_newbcast:6 row_mask:0xf bank_mask:0xf
    s_waitcnt vmcnt(7)
    s_nop 0
    v_mfma_f32_16x16x32_bf16 v[40:43], v[32:35], v[144:147], v[40:43]
    s_add_u32 s73, s73, 0x8000
    s_and_b32 s73, s73, 0x7ffff
    buffer_load_dwordx4 v[144:147], v5, s[36:39], s73 offen offset:0
    s_waitcnt vmcnt(7)
    v_mfma_f32_16x16x32_bf16 v[44:47], v[32:35], v[148:151], v[44:47]
    buffer_load_dwordx4 v[148:151], v5, s[36:39], s73 offen offset:256
    v_and_b32_dpp v36, v52, v12 row_newbcast:7 row_mask:0xf bank_mask:0xf
    v_and_b32_dpp v37, v52, v13 row_newbcast:7 row_mask:0xf bank_mask:0xf
    v_and_b32_dpp v38, v52, v14 row_newbcast:7 row_mask:0xf bank_mask:0xf
    v_and_b32_dpp v39, v52, v15 row_newbcast:7 row_mask:0xf bank_mask:0xf
    s_waitcnt vmcnt(7)
    s_nop 0
    v_mfma_f32_16x16x32_bf16 v[40:43], v[36:39], v[152:155], v[40:43]
    s_add_u32 s73, s73, 0x8000
    s_and_b32 s73, s73, 0x7ffff
    buffer_load_dwordx4 v[152:155], v5, s[36:39], s73 offen offset:0
    s_waitcnt vmcnt(7)
    v_mfma_f32_16x16x32_bf16 v[44:47], v[36:39], v[156:159], v[44:47]
    buffer_load_dwordx4 v[156:159], v5, s[36:39], s73 offen offset:256
    v_and_b32_dpp v32, v52, v12 row_newbcast:8 row_mask:0xf bank_mask:0xf
    v_and_b32_dpp v33, v52, v13 row_newbcast:8 row_mask:0xf bank_mask:0xf
    v_and_b32_dpp v34, v52, v14 row_newbcast:8 row_mask:0xf bank_mask:0xf
    v_and_b32_dpp v35, v52, v15 row_newbcast:8 row_mask:0xf bank_mask:0xf
    s_waitcnt vmcnt(7)
    s_nop 0
    v_mfma_f32_16x16x32_bf16 v[40:43], v[32:35], v[160:163], v[40:43]
    s_add_u32 s73, s73, 0x8000
    s_and_b32 s73, s73, 0x7ffff
    buffer_load_dwordx4 v[160:163], v5, s[36:39], s73 offen offset:0
    s_waitcnt vmcnt(7)
    v_mfma_f32_16x16x32_bf16 v[44:47], v[32:35], v[164:167], v[44:47]
    buffer_load_dwordx4 v[164:167], v5, s[36:39], s73 offen offset:256
    v_and_b32_dpp v36, v52, v12 row_newbcast:9 row_mask:0xf bank_mask:0xf
    v_and_b32_dpp v37, v52, v13 row_newbcast:9 row_mask:0xf bank_mask:0xf
    v_and_b32_dpp v38, v52, v14 row_newbcast:9 row_mask:0xf bank_mask:0xf
    v_and_b32_dpp v39, v52, v15 row_newbcast:9 row_mask:0xf bank_mask:0xf
    s_waitcnt vmcnt(7)
    s_nop 0
    v_mfma_f32_16x16x32_bf16 v[40:43], v[36:39], v[168:171], v[40:43]
    s_add_u32 s73, s73, 0x8000
    s_and_b32 s73, s73, 0x7ffff
    buffer_load_dwordx4 v[168:171], v5, s[36:39], s73 offen offset:0
    s_waitcnt vmcnt(7)
    v_mfma_f32_16x16x32_bf16 v[44:47], v[36:39], v[172:175], v[44:47]
    buffer_load_dwordx4 v[172:175], v5, s[36:39], s73 offen offset:256
    v_and_b32_dpp v32, v52, v12 row_newbcast:10 row_mask:0xf bank_mask:0xf
    v_and_b32_dpp v33, v52, v13 row_newbcast:10 row_mask:0xf bank_mask:0xf
    v_and_b32_dpp v34, v52, v14 row_newbcast:10 row_mask:0xf bank_mask:0xf
    v_and_b32_dpp v35, v52, v15 row_newbcast:10 row_mask:0xf bank_mask:0xf
    s_waitcnt vmcnt(7)
    s_nop 0
    v_mfma_f32_16x16x32_bf16 v[40:43], v[32:35], v[144:147], v[40:43]
    s_add_u32 s73, s73, 0x8000
    s_and_b32 s73, s73, 0x7ffff
    buffer_load_dwordx4 v[144:147], v5, s[36:39], s73 offen offset:0
    s_waitcnt vmcnt(7)
    v_mfma_f32_16x16x32_bf16 v[44:47], v[32:35], v[148:151], v[44:47]
    buffer_load_dwordx4 v[148:151], v5, s[36:39], s73 offen offset:256
    v_and_b32_dpp v36, v52, v12 row_newbcast:11 row_mask:0xf bank_mask:0xf
    v_and_b32_dpp v37, v52, v13 row_newbcast:11 row_mask:0xf bank_mask:0xf
    v_and_b32_dpp v38, v52, v14 row_newbcast:11 row_mask:0xf bank_mask:0xf
    v_and_b32_dpp v39, v52, v15 row_newbcast:11 row_mask:0xf bank_mask:0xf
    s_waitcnt vmcnt(7)
    s_nop 0
    v_mfma_f32_16x16x32_bf16 v[40:43], v[36:39], v[152:155], v[40:43]
    s_add_u32 s73, s73, 0x8000
    s_and_b32 s73, s73, 0x7ffff
    buffer_load_dwordx4 v[152:155], v5, s[36:39], s73 offen offset:0
    s_waitcnt vmcnt(7)
    v_mfma_f32_16x16x32_bf16 v[44:47], v[36:39], v[156:159], v[44:47]
    buffer_load_dwordx4 v[156:159], v5, s[36:39], s73 offen offset:256
    s_barrier
    s_cmp_eq_u32 s82, 0
    s_cbranch_scc0 L_kpo2_0
    s_mov_b32 s72, 0
    buffer_load_dwordx4 v[64:67], v2, s[28:31], s72 offen offset:0 nt
    buffer_load_dwordx4 v[68:71], v2, s[28:31], s72 offen offset:256 nt
    buffer_load_dwordx4 v[72:75], v2, s[28:31], s72 offen offset:2048 nt
    buffer_load_dwordx4 v[76:79], v2, s[28:31], s72 offen offset:2304 nt
    s_branch L_kpo2_x
L_kpo2_0:
    s_cmp_eq_u32 s82, 1
    s_cbranch_scc0 L_kpo2_1
    s_mov_b32 s72, 65536
    buffer_load_dwordx4 v[96:99], v2, s[28:31], s72 offen offset:0 nt
    buffer_load_dwordx4 v[100:103], v2, s[28:31], s72 offen offset:256 nt
    buffer_load_dwordx4 v[104:107], v2, s[28:31], s72 offen offset:2048 nt
    buffer_load_dwordx4 v[108:111], v2, s[28:31], s72 offen offset:2304 nt
    s_branch L_kpo2_x
L_kpo2_1:
    s_cmp_eq_u32 s82, 2
    s_cbranch_scc0 L_kpo2_2
    s_mov_b32 s72, 131072
    buffer_load_dwordx4 v[176:179], v2, s[28:31], s72 offen offset:0 nt
    buffer_load_dwordx4 v[180:183], v2, s[28:31], s72 offen offset:256 nt
    buffer_load_dwordx4 v[184:187], v2, s[28:31], s72 offen offset:2048 nt
    buffer_load_dwordx4 v[188:191], v2, s[28:31], s72 offen offset:2304 nt
    s_branch L_kpo2_x
L_kpo2_2:
    s_mov_b32 s72, 196608
    buffer_load_dwordx4 v[208:211], v2, s[28:31], s72 offen offset:0 nt
    buffer_load_dwordx4 v[212:215], v2, s[28:31], s72 offen offset:256 nt
    buffer_load_dwordx4 v[216:219], v2, s[28:31], s72 offen offset:2048 nt
    buffer_load_dwordx4 v[220:223], v2, s[28:31], s72 offen offset:2304 nt
L_kpo2_x:
    v_and_b32_dpp v32, v52, v12 row_newbcast:12 row_mask:0xf bank_mask:0xf
    v_and_b32_dpp v33, v52, v13 row_newbcast:12 row_mask:0xf bank_mask:0xf
    v_and_b32_dpp v34, v52, v14 row_newbcast:12 row_mask:0xf bank_mask:0xf
    v_and_b32_dpp v35, v52, v15 row_newbcast:12 row_mask:0xf bank_mask:0xf
    s_waitcnt vmcnt(11)
    s_nop 0
    v_mfma_f32_16x16x32_bf16 v[40:43], v[32:35], v[160:163], v[40:43]
    s_waitcnt vmcnt(10)
    v_mfma_f32_16x16x32_bf16 v[44:47], v[32:35], v[164:167], v[44:47]
    v_and_b32_dpp v36, v52, v12 row_newbcast:13 row_mask:0xf bank_mask:0xf
    v_and_b32_dpp v37, v52, v13 row_newbcast:13 row_mask:0xf bank_mask:0xf
    v_and_b32_dpp v38, v52, v14 row_newbcast:13 row_mask:0xf bank_mask:0xf
    v_and_b32_dpp v39, v52, v15 row_newbcast:13 row_mask:0xf bank_mask:0xf
    s_waitcnt vmcnt(9)
    s_nop 0
    v_mfma_f32_16x16x32_bf16 v[40:43], v[36:39], v[168:171], v[40:43]
    s_waitcnt vmcnt(8)
    v_mfma_f32_16x16x32_bf16 v[44:47], v[36:39], v[172:175], v[44:47]
    v_and_b32_dpp v32, v52, v12 row_newbcast:14 row_mask:0xf bank_mask:0xf
    v_and_b32_dpp v33, v52, v13 row_newbcast:14 row_mask:0xf bank_mask:0xf
    v_and_b32_dpp v34, v52, v14 row_newbcast:14 row_mask:0xf bank_mask:0xf
    v_and_b32_dpp v35, v52, v15 row_newbcast:14 row_mask:0xf bank_mask:0xf
    s_waitcnt vmcnt(7)
    s_nop 0
    v_mfma_f32_16x16x32_bf16 v[40:43], v[32:35], v[144:147], v[40:43]
    s_waitcnt vmcnt(6)
    v_mfma_f32_16x16x32_bf16 v[44:47], v[32:35], v[148:151], v[44:47]
    v_and_b32_dpp v36, v52, v12 row_newbcast:15 row_mask:0xf bank_mask:0xf
    v_and_b32_dpp v37, v52, v13 row_newbcast:15 row_mask:0xf bank_mask:0xf
    v_and_b32_dpp v38, v52, v14 row_newbcast:15 row_mask:0xf bank_mask:0xf
    v_and_b32_dpp v39, v52, v15 row_newbcast:15 row_mask:0xf bank_mask:0xf
    s_waitcnt vmcnt(5)
    s_nop 0
    v_mfma_f32_16x16x32_bf16 v[40:43], v[36:39], v[152:155], v[40:43]
    s_waitcnt vmcnt(4)
    v_mfma_f32_16x16x32_bf16 v[44:47], v[36:39], v[156:159], v[44:47]
    v_and_b32 v5, 0x1c0, v0
    v_lshlrev_b32 v5, 4, v5
    v_lshl_add_u32 v5, v6, 5, v5
    v_lshl_add_u32 v5, v7, 4, v5
    s_mov_b32 exec_hi, 0
    s_nop 0
    ds_write_b128 v5, v[40:43] offset:0
    s_nop 0
    ds_write_b128 v5, v[44:47] offset:512
    s_mov_b32 exec_hi, -1
    s_waitcnt lgkmcnt(0)
    s_branch L_join1
L_w7pro:
    s_cmp_lt_u32 s82, 1
    s_cbranch_scc1 L_kpre3
    s_mov_b32 s72, 0
    buffer_load_dwordx4 v[64:67], v2, s[28:31], s72 offen offset:0 nt
    buffer_load_dwordx4 v[68:71], v2, s[28:31], s72 offen offset:256 nt
    buffer_load_dwordx4 v[72:75], v2, s[28:31], s72 offen offset:2048 nt
    buffer_load_dwordx4 v[76:79], v2, s[28:31], s72 offen offset:2304 nt
    s_mov_b32 s72, 32768
    buffer_load_dwordx4 v[80:83], v2, s[28:31], s72 offen offset:0 nt
    buffer_load_dwordx4 v[84:87], v2, s[28:31], s72 offen offset:256 nt
    buffer_load_dwordx4 v[88:91], v2, s[28:31], s72 offen offset:2048 nt
    buffer_load_dwordx4 v[92:95], v2, s[28:31], s72 offen offset:2304 nt
    s_cmp_lt_u32 s82, 2
    s_cbranch_scc1 L_kpre3
    s_mov_b32 s72, 65536
    buffer_load_dwordx4 v[96:99], v2, s[28:31], s72 offen offset:0 nt
    buffer_load_dwordx4 v[100:103], v2, s[28:31], s72 offen offset:256 nt
    buffer_load_dwordx4 v[104:107], v2, s[28:31], s72 offen offset:2048 nt
    buffer_load_dwordx4 v[108:111], v2, s[28:31], s72 offen offset:2304 nt
    s_mov_b32 s72, 98304
    buffer_load_dwordx4 v[112:115], v2, s[28:31], s72 offen offset:0 nt
    buffer_load_dwordx4 v[116:119], v2, s[28:31], s72 offen offset:256 nt
    buffer_load_dwordx4 v[120:123], v2, s[28:31], s72 offen offset:2048 nt
    buffer_load_dwordx4 v[124:127], v2, s[28:31], s72 offen offset:2304 nt
    s_cmp_lt_u32 s82, 3
    s_cbranch_scc1 L_kpre3
    s_mov_b32 s72, 131072
    buffer_load_dwordx4 v[176:179], v2, s[28:31], s72 offen offset:0 nt
    buffer_load_dwordx4 v[180:183], v2, s[28:31], s72 offen offset:256 nt
    buffer_load_dwordx4 v[184:187], v2, s[28:31], s72 offen offset:2048 nt
    buffer_load_dwordx4 v[188:191], v2, s[28:31], s72 offen offset:2304 nt
    s_mov_b32 s72, 163840
    buffer_load_dwordx4 v[192:195], v2, s[28:31], s72 offen offset:0 nt
    buffer_load_dwordx4 v[196:199], v2, s[28:31], s72 offen offset:256 nt
    buffer_load_dwordx4 v[200:203], v2, s[28:31], s72 offen offset:2048 nt
    buffer_load_dwordx4 v[204:207], v2, s[28:31], s72 offen offset:2304 nt
L_kpre3:
    v_and_b32 v5, 31, v0
    v_lshlrev_b32 v5, 2, v5
    v_mov_b32 v7, -1
    ds_write_b32 v5, v7 offset:15488
    s_waitcnt lgkmcnt(0)
    s_barrier
    s_add_u32 s32, s8, s74
    s_addc_u32 s33, s9, 0
    s_mov_b32 s34, 0x80000
    s_mov_b32 s35, 0x20000
    v_and_b32 v8, 1, v0
    v_lshlrev_b32 v8, 4, v8
    v_mov_b32 v9, 0xffff
    v_lshlrev_b32 v8, v8, v9
    v_bfe_u32 v9, v0, 1, 3
    v_cmp_eq_u32 vcc, 0, v9
    s_nop 1
    v_cndmask_b32 v12, 0, v8, vcc
    v_cmp_eq_u32 vcc, 1, v9
    s_nop 1
    v_cndmask_b32 v13, 0, v8, vcc
    v_cmp_eq_u32 vcc, 2, v9
    s_nop 1
    v_cndmask_b32 v14, 0, v8, vcc
    v_cmp_eq_u32 vcc, 3, v9
    s_nop 1
    v_cndmask_b32 v15, 0, v8, vcc
    s_mul_i32 s74, s70, 229376
    s_add_u32 s40, s12, s74
    s_addc_u32 s41, s13, 0
    s_mov_b32 s42, 229376
    s_mov_b32 s43, 0x20000
    s_cmp_eq_u32 s68, 7
    s_cselect_b32 s42, 0, s42
    v_and_b32 v8, 8, v0
    v_lshlrev_b32 v8, 2, v8
    v_and_b32 v9, 48, v0
    v_lshrrev_b32 v9, 1, v9
    v_add_u32 v8, v8, v9
    v_mul_u32_u24 v4, 896, v8
    v_and_b32 v8, 7, v0
    v_lshl_add_u32 v4, v8, 4, v4
    v_and_b32 v8, 0x1c0, v0
    v_lshl_add_u32 v4, v8, 1, v4
    s_mov_b32 s78, 0x3db8aa3b
    s_mov_b32 s80, 0x05040100
    s_mov_b32 s81, 0x07060302
    s_mov_b32 s48, s26
    s_mov_b32 s49, s27
    s_mov_b32 s50, 0x110000
    s_mov_b32 s51, 0x20000
    s_and_b32 s75, s2, 7
    s_lshr_b32 s76, s2, 4
    s_lshl_b32 s76, s76, 3
    s_add_u32 s75, s75, s76
    s_bfe_u32 s76, s2, 0x10003
    s_lshl_b32 s79, s75, 1
    s_add_u32 s79, s79, s76
    s_cmp_lt_u32 s75, 28
    s_cselect_b32 s79, s79, -1
    s_sub_u32 s83, s2, 64
    s_cmp_lt_u32 s2, 8
    s_cbranch_scc0 L_w7z
    s_memrealtime s[66:67]
    s_lshl_b32 s44, s2, 14
    s_add_u32 s44, s44, 0x110000
    s_add_u32 s44, s44, s26
    s_addc_u32 s45, s27, 0
    s_waitcnt lgkmcnt(0)
    s_mul_i32 s67, s66, 0x2545f491
    v_mov_b32 v48, -1
    v_mov_b32 v56, 0
    v_mov_b32 v49, -1
    v_mov_b32 v57, 0
    v_mov_b32 v50, -1
    v_mov_b32 v58, 0
    v_mov_b32 v51, -1
    v_mov_b32 v59, 0
    v_lshrrev_b32 v7, 2, v1
    v_and_b32 v8, 3, v0
    v_lshlrev_b32 v8, 4, v8
    v_lshl_add_u32 v5, v7, 7, v8
    v_lshl_add_u32 v7, v7, 13, v8
    s_and_b32 s74, s2, 3
    s_lshl_b32 s74, s74, 15
    s_and_b32 s75, s2, 4
    s_lshl_b32 s75, s75, 11
    s_add_u32 s74, s74, s75
    s_add_u32 s74, s74, 0x80000
    buffer_store_dwordx4 v[48:51], v5, s[48:51], s74 offen offset:0 sc1
    buffer_store_dwordx4 v[48:51], v5, s[48:51], s74 offen offset:2048 sc1
    s_add_u32 s74, s74, 4096
    buffer_store_dwordx4 v[48:51], v5, s[48:51], s74 offen offset:0 sc1
    s_mov_b32 exec_hi, 0
    buffer_store_dwordx4 v[48:51], v5, s[48:51], s74 offen offset:2048 sc1
    s_add_u32 s74, s74, 12288
    s_mov_b32 exec_hi, -1
    buffer_store_dwordx4 v[48:51], v5, s[48:51], s74 offen offset:0 sc1
    buffer_store_dwordx4 v[48:51], v5, s[48:51], s74 offen offset:2048 sc1
    s_add_u32 s74, s74, 4096
    buffer_store_dwordx4 v[48:51], v5, s[48:51], s74 offen offset:0 sc1
    s_mov_b32 exec_hi, 0
    buffer_store_dwordx4 v[48:51], v5, s[48:51], s74 offen offset:2048 sc1
    s_lshl_b32 s74, s2, 16
    s_add_u32 s74, s74, 7168
    buffer_store_dwordx4 v[48:51], v7, s[48:51], s74 offen sc1
    s_mul_i32 s74, s2, 4352
    s_add_u32 s74, s74, 0x200000
    v_add_u32 v8, s74, v8
    s_mov_b32 exec_lo, 15
    global_store_dwordx4 v8, v[56:59], s[26:27] sc1
    s_mul_i32 s65, s66, 0x85ebca6b
    s_mul_i32 s64, s66, 0x9e3779b1
    s_lshr_b32 s65, s65, 12
    s_bfe_u32 s66, s64, 0xa000a
    s_lshl_b32 s66, s66, 18
    s_and_b32 s64, s64, 0x3ff
    s_lshl_b32 s64, s64, 2
    s_or_b32 s64, s64, s66
    s_or_b32 s64, s64, 0x10000
    s_bfe_u32 s66, s65, 0xa000a
    s_lshl_b32 s66, s66, 18
    s_and_b32 s65, s65, 0x3ff
    s_lshl_b32 s65, s65, 2
    s_or_b32 s65, s65, s66
    s_or_b32 s65, s65, 0x30002
    v_mov_b32 v52, s64
    v_mov_b32 v53, s65
    v_mov_b32 v55, s2
    s_cmp_eq_u32 s2, 0
    s_cselect_b32 exec_lo, 1, 0
    global_store_dwordx2 v56, v[52:53], s[24:25] offset:8 sc1
    s_mov_b64 exec, -1
L_w7z:
    s_barrier
    s_cmp_eq_u32 s82, 0
    s_cbranch_scc0 L_kpo4_0
    s_mov_b32 s72, 0
    buffer_load_dwordx4 v[64:67], v2, s[28:31], s72 offen offset:0 nt
    buffer_load_dwordx4 v[68:71], v2, s[28:31], s72 offen offset:256 nt
    buffer_load_dwordx4 v[72:75], v2, s[28:31], s72 offen offset:2048 nt
    buffer_load_dwordx4 v[76:79], v2, s[28:31], s72 offen offset:2304 nt
    s_branch L_kpo4_x
L_kpo4_0:
    s_cmp_eq_u32 s82, 1
    s_cbranch_scc0 L_kpo4_1
    s_mov_b32 s72, 65536
    buffer_load_dwordx4 v[96:99], v2, s[28:31], s72 offen offset:0 nt
    buffer_load_dwordx4 v[100:103], v2, s[28:31], s72 offen offset:256 nt
    buffer_load_dwordx4 v[104:107], v2, s[28:31], s72 offen offset:2048 nt
    buffer_load_dwordx4 v[108:111], v2, s[28:31], s72 offen offset:2304 nt
    s_branch L_kpo4_x
L_kpo4_1:
    s_cmp_eq_u32 s82, 2
    s_cbranch_scc0 L_kpo4_2
    s_mov_b32 s72, 131072
    buffer_load_dwordx4 v[176:179], v2, s[28:31], s72 offen offset:0 nt
    buffer_load_dwordx4 v[180:183], v2, s[28:31], s72 offen offset:256 nt
    buffer_load_dwordx4 v[184:187], v2, s[28:31], s72 offen offset:2048 nt
    buffer_load_dwordx4 v[188:191], v2, s[28:31], s72 offen offset:2304 nt
    s_branch L_kpo4_x
L_kpo4_2:
    s_mov_b32 s72, 196608
    buffer_load_dwordx4 v[208:211], v2, s[28:31], s72 offen offset:0 nt
    buffer_load_dwordx4 v[212:215], v2, s[28:31], s72 offen offset:256 nt
    buffer_load_dwordx4 v[216:219], v2, s[28:31], s72 offen offset:2048 nt
    buffer_load_dwordx4 v[220:223], v2, s[28:31], s72 offen offset:2304 nt
L_kpo4_x:
L_join1:
    s_setprio 3
    s_barrier
    v_lshlrev_b32 v5, 4, v1
    ds_read_b128 v[128:131], v5 offset:0
    ds_read_b128 v[132:135], v5 offset:1024
    ds_read_b128 v[136:139], v5 offset:2048
    ds_read_b128 v[140:143], v5 offset:3072
    ds_read_b128 v[144:147], v5 offset:4096
    ds_read_b128 v[148:151], v5 offset:5120
    ds_read_b128 v[152:155], v5 offset:6144
    v_lshlrev_b32 v6, 3, v0
    v_and_b32 v7, 0x1c0, v0
    v_lshlrev_b32 v7, 3, v7
    v_and_b32 v8, 48, v0
    v_lshl_add_u32 v7, v8, 2, v7
    v_and_b32 v8, 3, v0
    v_lshl_add_u32 v7, v8, 4, v7
    s_waitcnt lgkmcnt(5)
    v_add_f32 v128, v128, v132
    v_add_f32 v129, v129, v133
    v_add_f32 v130, v130, v134
    v_add_f32 v131, v131, v135
    s_waitcnt lgkmcnt(4)
    v_add_f32 v128, v128, v136
    v_add_f32 v129, v129, v137
    v_add_f32 v130, v130, v138
    v_add_f32 v131, v131, v139
    s_waitcnt lgkmcnt(3)
    v_add_f32 v128, v128, v140
    v_add_f32 v129, v129, v141
    v_add_f32 v130, v130, v142
    v_add_f32 v131, v131, v143
    s_waitcnt lgkmcnt(2)
    v_add_f32 v128, v128, v144
    v_add_f32 v129, v129, v145
    v_add_f32 v130, v130, v146
    v_add_f32 v131, v131, v147
    s_waitcnt lgkmcnt(1)
    v_add_f32 v128, v128, v148
    v_add_f32 v129, v129, v149
    v_add_f32 v130, v130, v150
    v_add_f32 v131, v131, v151
    s_waitcnt lgkmcnt(0)
    v_add_f32 v128, v128, v152
    v_add_f32 v129, v129, v153
    v_add_f32 v130, v130, v154
    v_add_f32 v131, v131, v155
    v_cvt_pk_bf16_f32 v128, v128, v129
    v_cvt_pk_bf16_f32 v129, v130, v131
    ds_write_b64 v6, v[128:129] offset:7168
    s_waitcnt lgkmcnt(0)
    ds_read_b128 v[16:19], v7 offset:7168
    ds_read_b128 v[20:23], v7 offset:7424
    s_waitcnt lgkmcnt(0)
    s_cmp_eq_u32 s82, 1
    s_cbranch_scc1 L_kr1
    s_cmp_eq_u32 s82, 2
    s_cbranch_scc1 L_kr2
    s_cmp_eq_u32 s82, 3
    s_cbranch_scc1 L_kr3
    s_mov_b32 s72, 32768
    buffer_load_dwordx4 v[80:83], v2, s[28:31], s72 offen offset:0 nt
    buffer_load_dwordx4 v[84:87], v2, s[28:31], s72 offen offset:256 nt
    buffer_load_dwordx4 v[88:91], v2, s[28:31], s72 offen offset:2048 nt
    buffer_load_dwordx4 v[92:95], v2, s[28:31], s72 offen offset:2304 nt
    s_mov_b32 s72, 65536
    buffer_load_dwordx4 v[96:99], v2, s[28:31], s72 offen offset:0 nt
    buffer_load_dwordx4 v[100:103], v2, s[28:31], s72 offen offset:256 nt
    buffer_load_dwordx4 v[104:107], v2, s[28:31], s72 offen offset:2048 nt
    buffer_load_dwordx4 v[108:111], v2, s[28:31], s72 offen offset:2304 nt
L_kr1:
    s_mov_b32 s72, 98304
    buffer_load_dwordx4 v[112:115], v2, s[28:31], s72 offen offset:0 nt
    buffer_load_dwordx4 v[116:119], v2, s[28:31], s72 offen offset:256 nt
    buffer_load_dwordx4 v[120:123], v2, s[28:31], s72 offen offset:2048 nt
    buffer_load_dwordx4 v[124:127], v2, s[28:31], s72 offen offset:2304 nt
    s_mov_b32 s72, 131072
    buffer_load_dwordx4 v[176:179], v2, s[28:31], s72 offen offset:0 nt
    buffer_load_dwordx4 v[180:183], v2, s[28:31], s72 offen offset:256 nt
    buffer_load_dwordx4 v[184:187], v2, s[28:31], s72 offen offset:2048 nt
    buffer_load_dwordx4 v[188:191], v2, s[28:31], s72 offen offset:2304 nt
L_kr2:
    s_mov_b32 s72, 163840
    buffer_load_dwordx4 v[192:195], v2, s[28:31], s72 offen offset:0 nt
    buffer_load_dwordx4 v[196:199], v2, s[28:31], s72 offen offset:256 nt
    buffer_load_dwordx4 v[200:203], v2, s[28:31], s72 offen offset:2048 nt
    buffer_load_dwordx4 v[204:207], v2, s[28:31], s72 offen offset:2304 nt
    s_mov_b32 s72, 196608
    buffer_load_dwordx4 v[208:211], v2, s[28:31], s72 offen offset:0 nt
    buffer_load_dwordx4 v[212:215], v2, s[28:31], s72 offen offset:256 nt
    buffer_load_dwordx4 v[216:219], v2, s[28:31], s72 offen offset:2048 nt
    buffer_load_dwordx4 v[220:223], v2, s[28:31], s72 offen offset:2304 nt
L_kr3:
    s_mov_b32 s72, 229376
    buffer_load_dwordx4 v[224:227], v2, s[28:31], s72 offen offset:0 nt
    buffer_load_dwordx4 v[228:231], v2, s[28:31], s72 offen offset:256 nt
    buffer_load_dwordx4 v[232:235], v2, s[28:31], s72 offen offset:2048 nt
    buffer_load_dwordx4 v[236:239], v2, s[28:31], s72 offen offset:2304 nt
    s_mov_b32 s72, 262144
    buffer_load_dwordx4 v[240:243], v2, s[28:31], s72 offen offset:0 nt
    buffer_load_dwordx4 v[244:247], v2, s[28:31], s72 offen offset:256 nt
    buffer_load_dwordx4 v[248:251], v2, s[28:31], s72 offen offset:2048 nt
    buffer_load_dwordx4 v[252:255], v2, s[28:31], s72 offen offset:2304 nt
    s_waitcnt vmcnt(35)
    v_mfma_f32_16x16x32_bf16 v[32:35], v[64:67], v[16:19], 0
    s_mov_b32 s72, 294912
    buffer_load_dwordx4 v[64:67], v2, s[28:31], s72 offen offset:0 nt
    s_waitcnt vmcnt(35)
    v_mfma_f32_16x16x32_bf16 v[32:35], v[68:71], v[20:23], v[32:35]
    buffer_load_dwordx4 v[68:71], v2, s[28:31], s72 offen offset:256 nt
    s_waitcnt vmcnt(35)
    v_mfma_f32_16x16x32_bf16 v[36:39], v[72:75], v[16:19], 0
    buffer_load_dwordx4 v[72:75], v2, s[28:31], s72 offen offset:2048 nt
    s_waitcnt vmcnt(35)
    v_mfma_f32_16x16x32_bf16 v[36:39], v[76:79], v[20:23], v[36:39]
    buffer_load_dwordx4 v[76:79], v2, s[28:31], s72 offen offset:2304 nt
    s_waitcnt vmcnt(35)
    v_mfma_f32_16x16x32_bf16 v[40:43], v[80:83], v[16:19], 0
    s_mov_b32 s72, 327680
    buffer_load_dwordx4 v[80:83], v2, s[28:31], s72 offen offset:0 nt
    s_waitcnt vmcnt(35)
    v_mfma_f32_16x16x32_bf16 v[40:43], v[84:87], v[20:23], v[40:43]
    buffer_load_dwordx4 v[84:87], v2, s[28:31], s72 offen offset:256 nt
    s_waitcnt vmcnt(35)
    v_mfma_f32_16x16x32_bf16 v[44:47], v[88:91], v[16:19], 0
    buffer_load_dwordx4 v[88:91], v2, s[28:31], s72 offen offset:2048 nt
    s_waitcnt vmcnt(35)
    v_mfma_f32_16x16x32_bf16 v[44:47], v[92:95], v[20:23], v[44:47]
    buffer_load_dwordx4 v[92:95], v2, s[28:31], s72 offen offset:2304 nt
    s_waitcnt vmcnt(35)
    v_mfma_f32_16x16x32_bf16 v[48:51], v[96:99], v[16:19], 0
    s_mov_b32 s72, 360448
    buffer_load_dwordx4 v[96:99], v2, s[28:31], s72 offen offset:0 nt
    s_waitcnt vmcnt(35)
    v_mfma_f32_16x16x32_bf16 v[48:51], v[100:103], v[20:23], v[48:51]
    buffer_load_dwordx4 v[100:103], v2, s[28:31], s72 offen offset:256 nt
    s_waitcnt vmcnt(35)
    v_mfma_f32_16x16x32_bf16 v[52:55], v[104:107], v[16:19], 0
    buffer_load_dwordx4 v[104:107], v2, s[28:31], s72 offen offset:2048 nt
    s_waitcnt vmcnt(35)
    v_mfma_f32_16x16x32_bf16 v[52:55], v[108:111], v[20:23], v[52:55]
    buffer_load_dwordx4 v[108:111], v2, s[28:31], s72 offen offset:2304 nt
    v_mov_b32_dpp v8, v32 quad_perm:[0,0,0,0] row_mask:0xf bank_mask:0xf
    v_mov_b32_dpp v9, v36 quad_perm:[0,0,0,0] row_mask:0xf bank_mask:0xf
    v_mov_b32_dpp v10, v40 quad_perm:[0,0,0,0] row_mask:0xf bank_mask:0xf
    v_mov_b32_dpp v11, v44 quad_perm:[0,0,0,0] row_mask:0xf bank_mask:0xf
    v_add_f32_dpp v8, v33, v8 quad_perm:[1,1,1,1] row_mask:0xf bank_mask:0xf
    v_add_f32_dpp v9, v37, v9 quad_perm:[1,1,1,1] row_mask:0xf bank_mask:0xf
    v_add_f32_dpp v10, v41, v10 quad_perm:[1,1,1,1] row_mask:0xf bank_mask:0xf
    v_add_f32_dpp v11, v45, v11 quad_perm:[1,1,1,1] row_mask:0xf bank_mask:0xf
    v_add_f32_dpp v8, v34, v8 quad_perm:[2,2,2,2] row_mask:0xf bank_mask:0xf
    v_add_f32_dpp v9, v38, v9 quad_perm:[2,2,2,2] row_mask:0xf bank_mask:0xf
    v_add_f32_dpp v10, v42, v10 quad_perm:[2,2,2,2] row_mask:0xf bank_mask:0xf
    v_add_f32_dpp v11, v46, v11 quad_perm:[2,2,2,2] row_mask:0xf bank_mask:0xf
    v_add_f32_dpp v24, v35, v8 quad_perm:[3,3,3,3] row_mask:0xf bank_mask:0x1
    s_nop 1
    v_add_f32_dpp v24, v39, v9 quad_perm:[3,3,3,3] row_mask:0xf bank_mask:0x2
    s_nop 1
    v_add_f32_dpp v24, v43, v10 quad_perm:[3,3,3,3] row_mask:0xf bank_mask:0x4
    s_nop 1
    v_add_f32_dpp v24, v47, v11 quad_perm:[3,3,3,3] row_mask:0xf bank_mask:0x8
    s_waitcnt vmcnt(35)
    v_mfma_f32_16x16x32_bf16 v[56:59], v[112:115], v[16:19], 0
    s_mov_b32 s72, 393216
    buffer_load_dwordx4 v[112:115], v2, s[28:31], s72 offen offset:0 nt
    s_waitcnt vmcnt(35)
    v_mfma_f32_16x16x32_bf16 v[56:59], v[116:119], v[20:23], v[56:59]
    buffer_load_dwordx4 v[116:119], v2, s[28:31], s72 offen offset:256 nt
    s_waitcnt vmcnt(35)
    v_mfma_f32_16x16x32_bf16 v[60:63], v[120:123], v[16:19], 0
    buffer_load_dwordx4 v[120:123], v2, s[28:31], s72 offen offset:2048 nt
    s_waitcnt vmcnt(35)
    v_mfma_f32_16x16x32_bf16 v[60:63], v[124:127], v[20:23], v[60:63]
    buffer_load_dwordx4 v[124:127], v2, s[28:31], s72 offen offset:2304 nt
    s_waitcnt vmcnt(35)
    v_mfma_f32_16x16x32_bf16 v[32:35], v[176:179], v[16:19], 0
    s_waitcnt vmcnt(34)
    v_mfma_f32_16x16x32_bf16 v[32:35], v[180:183], v[20:23], v[32:35]
    s_waitcnt vmcnt(33)
    v_mfma_f32_16x16x32_bf16 v[36:39], v[184:187], v[16:19], 0
    s_waitcnt vmcnt(32)
    v_mfma_f32_16x16x32_bf16 v[36:39], v[188:191], v[20:23], v[36:39]
    v_mov_b32_dpp v8, v48 quad_perm:[0,0,0,0] row_mask:0xf bank_mask:0xf
    v_mov_b32_dpp v9, v52 quad_perm:[0,0,0,0] row_mask:0xf bank_mask:0xf
    v_mov_b32_dpp v10, v56 quad_perm:[0,0,0,0] row_mask:0xf bank_mask:0xf
    v_mov_b32_dpp v11, v60 quad_perm:[0,0,0,0] row_mask:0xf bank_mask:0xf
    v_add_f32_dpp v8, v49, v8 quad_perm:[1,1,1,1] row_mask:0xf bank_mask:0xf
    v_add_f32_dpp v9, v53, v9 quad_perm:[1,1,1,1] row_mask:0xf bank_mask:0xf
    v_add_f32_dpp v10, v57, v10 quad_perm:[1,1,1,1] row_mask:0xf bank_mask:0xf
    v_add_f32_dpp v11, v61, v11 quad_perm:[1,1,1,1] row_mask:0xf bank_mask:0xf
    v_add_f32_dpp v8, v50, v8 quad_perm:[2,2,2,2] row_mask:0xf bank_mask:0xf
    v_add_f32_dpp v9, v54, v9 quad_perm:[2,2,2,2] row_mask:0xf bank_mask:0xf
    v_add_f32_dpp v10, v58, v10 quad_perm:[2,2,2,2] row_mask:0xf bank_mask:0xf
    v_add_f32_dpp v11, v62, v11 quad_perm:[2,2,2,2] row_mask:0xf bank_mask:0xf
    v_add_f32_dpp v25, v51, v8 quad_perm:[3,3,3,3] row_mask:0xf bank_mask:0x1
    s_nop 1
    v_add_f32_dpp v25, v55, v9 quad_perm:[3,3,3,3] row_mask:0xf bank_mask:0x2
    s_nop 1
    v_add_f32_dpp v25, v59, v10 quad_perm:[3,3,3,3] row_mask:0xf bank_mask:0x4
    s_nop 1
    v_add_f32_dpp v25, v63, v11 quad_perm:[3,3,3,3] row_mask:0xf bank_mask:0x8
    s_waitcnt vmcnt(31)
    v_mfma_f32_16x16x32_bf16 v[40:43], v[192:195], v[16:19], 0
    s_waitcnt vmcnt(30)
    v_mfma_f32_16x16x32_bf16 v[40:43], v[196:199], v[20:23], v[40:43]
    s_waitcnt vmcnt(29)
    v_mfma_f32_16x16x32_bf16 v[44:47], v[200:203], v[16:19], 0
    s_waitcnt vmcnt(28)
    v_mfma_f32_16x16x32_bf16 v[44:47], v[204:207], v[20:23], v[44:47]
    s_waitcnt vmcnt(27)
    v_mfma_f32_16x16x32_bf16 v[48:51], v[208:211], v[16:19], 0
    s_waitcnt vmcnt(26)
    v_mfma_f32_16x16x32_bf16 v[48:51], v[212:215], v[20:23], v[48:51]
    s_waitcnt vmcnt(25)
    v_mfma_f32_16x16x32_bf16 v[52:55], v[216:219], v[16:19], 0
    s_waitcnt vmcnt(24)
    v_mfma_f32_16x16x32_bf16 v[52:55], v[220:223], v[20:23], v[52:55]
    v_mov_b32_dpp v8, v32 quad_perm:[0,0,0,0] row_mask:0xf bank_mask:0xf
    v_mov_b32_dpp v9, v36 quad_perm:[0,0,0,0] row_mask:0xf bank_mask:0xf
    v_mov_b32_dpp v10, v40 quad_perm:[0,0,0,0] row_mask:0xf bank_mask:0xf
    v_mov_b32_dpp v11, v44 quad_perm:[0,0,0,0] row_mask:0xf bank_mask:0xf
    v_add_f32_dpp v8, v33, v8 quad_perm:[1,1,1,1] row_mask:0xf bank_mask:0xf
    v_add_f32_dpp v9, v37, v9 quad_perm:[1,1,1,1] row_mask:0xf bank_mask:0xf
    v_add_f32_dpp v10, v41, v10 quad_perm:[1,1,1,1] row_mask:0xf bank_mask:0xf
    v_add_f32_dpp v11, v45, v11 quad_perm:[1,1,1,1] row_mask:0xf bank_mask:0xf
    v_add_f32_dpp v8, v34, v8 quad_perm:[2,2,2,2] row_mask:0xf bank_mask:0xf
    v_add_f32_dpp v9, v38, v9 quad_perm:[2,2,2,2] row_mask:0xf bank_mask:0xf
    v_add_f32_dpp v10, v42, v10 quad_perm:[2,2,2,2] row_mask:0xf bank_mask:0xf
    v_add_f32_dpp v11, v46, v11 quad_perm:[2,2,2,2] row_mask:0xf bank_mask:0xf
    v_add_f32_dpp v26, v35, v8 quad_perm:[3,3,3,3] row_mask:0xf bank_mask:0x1
    s_nop 1
    v_add_f32_dpp v26, v39, v9 quad_perm:[3,3,3,3] row_mask:0xf bank_mask:0x2
    s_nop 1
    v_add_f32_dpp v26, v43, v10 quad_perm:[3,3,3,3] row_mask:0xf bank_mask:0x4
    s_nop 1
    v_add_f32_dpp v26, v47, v11 quad_perm:[3,3,3,3] row_mask:0xf bank_mask:0x8
    s_waitcnt vmcnt(23)
    v_mfma_f32_16x16x32_bf16 v[56:59], v[224:227], v[16:19], 0
    s_waitcnt vmcnt(22)
    v_mfma_f32_16x16x32_bf16 v[56:59], v[228:231], v[20:23], v[56:59]
    s_waitcnt vmcnt(21)
    v_mfma_f32_16x16x32_bf16 v[60:63], v[232:235], v[16:19], 0
    s_waitcnt vmcnt(20)
    v_mfma_f32_16x16x32_bf16 v[60:63], v[236:239], v[20:23], v[60:63]
    s_waitcnt vmcnt(19)
    v_mfma_f32_16x16x32_bf16 v[32:35], v[240:243], v[16:19], 0
    s_setprio 2
    s_waitcnt vmcnt(18)
    v_mfma_f32_16x16x32_bf16 v[32:35], v[244:247], v[20:23], v[32:35]
    s_waitcnt vmcnt(17)
    v_mfma_f32_16x16x32_bf16 v[36:39], v[248:251], v[16:19], 0
    s_waitcnt vmcnt(16)
    v_mfma_f32_16x16x32_bf16 v[36:39], v[252:255], v[20:23], v[36:39]
    s_cmp_eq_u32 s68, 7
    s_cselect_b32 s0, s2, 256
    s_cmp_lt_u32 s0, 8
    s_nop 4
    s_cbranch_scc0 L_nolf
    s_mov_b32 s15, 8
    s_mov_b32 s52, s67
    s_mov_b32 s53, s67
    s_load_dword s52, s[44:45], 0x0
    s_load_dword s53, s[44:45], 0x2000
    s_waitcnt lgkmcnt(1)
    s_mov_b64 s[0:1], s[52:53]
    s_cmp_lg_u32 s1, s67
    s_addc_u32 s15, s15, 0
    s_cmp_lg_u32 s0, s67
    s_subb_u32 s15, s15, 0
    s_waitcnt lgkmcnt(0)
    s_mov_b32 s52, s67
    s_mov_b32 s53, s67
    s_load_dword s53, s[44:45], 0x2380
    s_load_dword s52, s[44:45], 0x380
    s_waitcnt lgkmcnt(1)
    s_mov_b64 s[0:1], s[52:53]
    s_cmp_lg_u32 s1, s67
    s_addc_u32 s15, s15, 0
    s_cmp_lg_u32 s0, s67
    s_subb_u32 s15, s15, 0
    s_waitcnt lgkmcnt(0)
    s_mov_b32 s52, s67
    s_mov_b32 s53, s67
    s_load_dword s52, s[44:45], 0x700
    s_load_dword s53, s[44:45], 0x2700
    s_waitcnt lgkmcnt(1)
    s_mov_b64 s[0:1], s[52:53]
    s_cmp_lg_u32 s1, s67
    s_addc_u32 s15, s15, 0
    s_cmp_lg_u32 s0, s67
    s_subb_u32 s15, s15, 0
    s_waitcnt lgkmcnt(0)
    s_mov_b32 s52, s67
    s_mov_b32 s53, s67
    s_load_dword s53, s[44:45], 0x2a80
    s_load_dword s52, s[44:45], 0xa80
    s_waitcnt lgkmcnt(1)
    s_mov_b64 s[0:1], s[52:53]
    s_cmp_lg_u32 s1, s67
    s_addc_u32 s15, s15, 0
    s_cmp_lg_u32 s0, s67
    s_subb_u32 s15, s15, 0
    s_waitcnt lgkmcnt(0)
    s_getreg_b32 s0, hwreg(HW_REG_XCC_ID, 0, 3)
    s_sub_u32 s14, 16, s15
    s_bitcmp1_b32 s0, 2
    s_cselect_b32 s15, s14, s15
    s_or_b32 s15, s15, 0x80
    s_lshl_b32 s0, s0, 4
    s_or_b32 s15, s15, s0
    v_mov_b32 v5, s15
    v_mov_b32 v6, s2
    s_waitcnt vmcnt(0)
    s_mov_b64 exec, 1
    global_store_byte v6, v5, s[24:25] sc1
    s_mov_b64 exec, -1
L_nolf:
    v_mov_b32_dpp v8, v48 quad_perm:[0,0,0,0] row_mask:0xf bank_mask:0xf
    v_mov_b32_dpp v9, v52 quad_perm:[0,0,0,0] row_mask:0xf bank_mask:0xf
    v_mov_b32_dpp v10, v56 quad_perm:[0,0,0,0] row_mask:0xf bank_mask:0xf
    v_mov_b32_dpp v11, v60 quad_perm:[0,0,0,0] row_mask:0xf bank_mask:0xf
    v_add_f32_dpp v8, v49, v8 quad_perm:[1,1,1,1] row_mask:0xf bank_mask:0xf
    v_add_f32_dpp v9, v53, v9 quad_perm:[1,1,1,1] row_mask:0xf bank_mask:0xf
    v_add_f32_dpp v10, v57, v10 quad_perm:[1,1,1,1] row_mask:0xf bank_mask:0xf
    v_add_f32_dpp v11, v61, v11 quad_perm:[1,1,1,1] row_mask:0xf bank_mask:0xf
    v_add_f32_dpp v8, v50, v8 quad_perm:[2,2,2,2] row_mask:0xf bank_mask:0xf
    v_add_f32_dpp v9, v54, v9 quad_perm:[2,2,2,2] row_mask:0xf bank_mask:0xf
    v_add_f32_dpp v10, v58, v10 quad_perm:[2,2,2,2] row_mask:0xf bank_mask:0xf
    v_add_f32_dpp v11, v62, v11 quad_perm:[2,2,2,2] row_mask:0xf bank_mask:0xf
    v_add_f32_dpp v27, v51, v8 quad_perm:[3,3,3,3] row_mask:0xf bank_mask:0x1
    s_nop 1
    v_add_f32_dpp v27, v55, v9 quad_perm:[3,3,3,3] row_mask:0xf bank_mask:0x2
    s_nop 1
    v_add_f32_dpp v27, v59, v10 quad_perm:[3,3,3,3] row_mask:0xf bank_mask:0x4
    s_nop 1
    v_add_f32_dpp v27, v63, v11 quad_perm:[3,3,3,3] row_mask:0xf bank_mask:0x8
    s_waitcnt vmcnt(15)
    v_mfma_f32_16x16x32_bf16 v[40:43], v[64:67], v[16:19], 0
    s_mov_b32 s72, 425984
    buffer_load_dwordx4 v[64:67], v2, s[28:31], s72 offen offset:0 nt
    s_waitcnt vmcnt(15)
    v_mfma_f32_16x16x32_bf16 v[40:43], v[68:71], v[20:23], v[40:43]
    buffer_load_dwordx4 v[68:71], v2, s[28:31], s72 offen offset:256 nt
    s_waitcnt vmcnt(15)
    v_mfma_f32_16x16x32_bf16 v[44:47], v[72:75], v[16:19], 0
    buffer_load_dwordx4 v[72:75], v2, s[28:31], s72 offen offset:2048 nt
    s_mov_b32 s73, 0
    buffer_load_dwordx4 v[128:131], v4, s[40:43], s73 offen offset:0
    s_waitcnt vmcnt(16)
    v_mfma_f32_16x16x32_bf16 v[44:47], v[76:79], v[20:23], v[44:47]
    buffer_load_dwordx4 v[76:79], v2, s[28:31], s72 offen offset:2304 nt
    s_waitcnt vmcnt(16)
    v_mfma_f32_16x16x32_bf16 v[48:51], v[80:83], v[16:19], 0
    s_mov_b32 s72, 458752
    buffer_load_dwordx4 v[80:83], v2, s[28:31], s72 offen offset:0 nt
    buffer_load_dwordx4 v[132:135], v4, s[40:43], s73 offen offset:896
    s_waitcnt vmcnt(17)
    v_mfma_f32_16x16x32_bf16 v[48:51], v[84:87], v[20:23], v[48:51]
    buffer_load_dwordx4 v[84:87], v2, s[28:31], s72 offen offset:256 nt
    s_waitcnt vmcnt(17)
    v_mfma_f32_16x16x32_bf16 v[52:55], v[88:91], v[16:19], 0
    buffer_load_dwordx4 v[88:91], v2, s[28:31], s72 offen offset:2048 nt
    buffer_load_dwordx4 v[136:139], v4, s[40:43], s73 offen offset:1792
    s_waitcnt vmcnt(18)
    v_mfma_f32_16x16x32_bf16 v[52:55], v[92:95], v[20:23], v[52:55]
    buffer_load_dwordx4 v[92:95], v2, s[28:31], s72 offen offset:2304 nt
    v_mov_b32_dpp v8, v32 quad_perm:[0,0,0,0] row_mask:0xf bank_mask:0xf
    v_mov_b32_dpp v9, v36 quad_perm:[0,0,0,0] row_mask:0xf bank_mask:0xf
    v_mov_b32_dpp v10, v40 quad_perm:[0,0,0,0] row_mask:0xf bank_mask:0xf
    v_mov_b32_dpp v11, v44 quad_perm:[0,0,0,0] row_mask:0xf bank_mask:0xf
    v_add_f32_dpp v8, v33, v8 quad_perm:[1,1,1,1] row_mask:0xf bank_mask:0xf
    v_add_f32_dpp v9, v37, v9 quad_perm:[1,1,1,1] row_mask:0xf bank_mask:0xf
    v_add_f32_dpp v10, v41, v10 quad_perm:[1,1,1,1] row_mask:0xf bank_mask:0xf
    v_add_f32_dpp v11, v45, v11 quad_perm:[1,1,1,1] row_mask:0xf bank_mask:0xf
    v_add_f32_dpp v8, v34, v8 quad_perm:[2,2,2,2] row_mask:0xf bank_mask:0xf
    v_add_f32_dpp v9, v38, v9 quad_perm:[2,2,2,2] row_mask:0xf bank_mask:0xf
    v_add_f32_dpp v10, v42, v10 quad_perm:[2,2,2,2] row_mask:0xf bank_mask:0xf
    v_add_f32_dpp v11, v46, v11 quad_perm:[2,2,2,2] row_mask:0xf bank_mask:0xf
    v_add_f32_dpp v28, v35, v8 quad_perm:[3,3,3,3] row_mask:0xf bank_mask:0x1
    s_nop 1
    v_add_f32_dpp v28, v39, v9 quad_perm:[3,3,3,3] row_mask:0xf bank_mask:0x2
    s_nop 1
    v_add_f32_dpp v28, v43, v10 quad_perm:[3,3,3,3] row_mask:0xf bank_mask:0x4
    s_nop 1
    v_add_f32_dpp v28, v47, v11 quad_perm:[3,3,3,3] row_mask:0xf bank_mask:0x8
    s_waitcnt vmcnt(18)
    v_mfma_f32_16x16x32_bf16 v[56:59], v[96:99], v[16:19], 0
    s_mov_b32 s72, 491520
    buffer_load_dwordx4 v[96:99], v2, s[28:31], s72 offen offset:0 nt
    buffer_load_dwordx4 v[140:143], v4, s[40:43], s73 offen offset:2688
    s_waitcnt vmcnt(19)
    v_mfma_f32_16x16x32_bf16 v[56:59], v[100:103], v[20:23], v[56:59]
    buffer_load_dwordx4 v[100:103], v2, s[28:31], s72 offen offset:256 nt
    s_waitcnt vmcnt(19)
    v_mfma_f32_16x16x32_bf16 v[60:63], v[104:107], v[16:19], 0
    buffer_load_dwordx4 v[104:107], v2, s[28:31], s72 offen offset:2048 nt
    s_mov_b32 s73, 3584
    buffer_load_dwordx4 v[144:147], v4, s[40:43], s73 offen offset:0
    s_waitcnt vmcnt(20)
    v_mfma_f32_16x16x32_bf16 v[60:63], v[108:111], v[20:23], v[60:63]
    buffer_load_dwordx4 v[108:111], v2, s[28:31], s72 offen offset:2304 nt
    s_waitcnt vmcnt(20)
    v_mfma_f32_16x16x32_bf16 v[32:35], v[112:115], v[16:19], 0
    s_mov_b32 s72, 0
    buffer_load_dwordx4 v[112:115], v3, s[32:35], s72 offen offset:0 nt
    buffer_load_dwordx4 v[148:151], v4, s[40:43], s73 offen offset:896
    s_waitcnt vmcnt(21)
    v_mfma_f32_16x16x32_bf16 v[32:35], v[116:119], v[20:23], v[32:35]
    buffer_load_dwordx4 v[116:119], v3, s[32:35], s72 offen offset:256 nt
    s_waitcnt vmcnt(21)
    v_mfma_f32_16x16x32_bf16 v[36:39], v[120:123], v[16:19], 0
    buffer_load_dwordx4 v[120:123], v3, s[32:35], s72 offen offset:2048 nt
    buffer_load_dwordx4 v[152:155], v4, s[40:43], s73 offen offset:1792
    s_waitcnt vmcnt(22)
    v_mfma_f32_16x16x32_bf16 v[36:39], v[124:127], v[20:23], v[36:39]
    buffer_load_dwordx4 v[124:127], v3, s[32:35], s72 offen offset:2304 nt
    v_mov_b32_dpp v8, v48 quad_perm:[0,0,0,0] row_mask:0xf bank_mask:0xf
    v_mov_b32_dpp v9, v52 quad_perm:[0,0,0,0] row_mask:0xf bank_mask:0xf
    v_mov_b32_dpp v10, v56 quad_perm:[0,0,0,0] row_mask:0xf bank_mask:0xf
    v_mov_b32_dpp v11, v60 quad_perm:[0,0,0,0] row_mask:0xf bank_mask:0xf
    v_add_f32_dpp v8, v49, v8 quad_perm:[1,1,1,1] row_mask:0xf bank_mask:0xf
    v_add_f32_dpp v9, v53, v9 quad_perm:[1,1,1,1] row_mask:0xf bank_mask:0xf
    v_add_f32_dpp v10, v57, v10 quad_perm:[1,1,1,1] row_mask:0xf bank_mask:0xf
    v_add_f32_dpp v11, v61, v11 quad_perm:[1,1,1,1] row_mask:0xf bank_mask:0xf
    v_add_f32_dpp v8, v50, v8 quad_perm:[2,2,2,2] row_mask:0xf bank_mask:0xf
    v_add_f32_dpp v9, v54, v9 quad_perm:[2,2,2,2] row_mask:0xf bank_mask:0xf
    v_add_f32_dpp v10, v58, v10 quad_perm:[2,2,2,2] row_mask:0xf bank_mask:0xf
    v_add_f32_dpp v11, v62, v11 quad_perm:[2,2,2,2] row_mask:0xf bank_mask:0xf
    v_add_f32_dpp v29, v51, v8 quad_perm:[3,3,3,3] row_mask:0xf bank_mask:0x1
    s_nop 1
    v_add_f32_dpp v29, v55, v9 quad_perm:[3,3,3,3] row_mask:0xf bank_mask:0x2
    s_nop 1
    v_add_f32_dpp v29, v59, v10 quad_perm:[3,3,3,3] row_mask:0xf bank_mask:0x4
    s_nop 1
    v_add_f32_dpp v29, v63, v11 quad_perm:[3,3,3,3] row_mask:0xf bank_mask:0x8
    s_waitcnt vmcnt(22)
    v_mfma_f32_16x16x32_bf16 v[40:43], v[64:67], v[16:19], 0
    s_mov_b32 s72, 32768
    buffer_load_dwordx4 v[64:67], v3, s[32:35], s72 offen offset:0 nt
    buffer_load_dwordx4 v[156:159], v4, s[40:43], s73 offen offset:2688
    s_waitcnt vmcnt(23)
    v_mfma_f32_16x16x32_bf16 v[40:43], v[68:71], v[20:23], v[40:43]
    buffer_load_dwordx4 v[68:71], v3, s[32:35], s72 offen offset:256 nt
    s_waitcnt vmcnt(23)
    v_mfma_f32_16x16x32_bf16 v[44:47], v[72:75], v[16:19], 0
    buffer_load_dwordx4 v[72:75], v3, s[32:35], s72 offen offset:2048 nt
    s_mov_b32 s73, 57344
    buffer_load_dwordx4 v[160:163], v4, s[40:43], s73 offen offset:0
    s_waitcnt vmcnt(23)
    v_mfma_f32_16x16x32_bf16 v[44:47], v[76:79], v[20:23], v[44:47]
    buffer_load_dwordx4 v[76:79], v3, s[32:35], s72 offen offset:2304 nt
    s_waitcnt vmcnt(23)
    v_mfma_f32_16x16x32_bf16 v[48:51], v[80:83], v[16:19], 0
    s_mov_b32 s72, 65536
    buffer_load_dwordx4 v[80:83], v3, s[32:35], s72 offen offset:0 nt
    buffer_load_dwordx4 v[164:167], v4, s[40:43], s73 offen offset:896
    s_waitcnt vmcnt(23)
    v_mfma_f32_16x16x32_bf16 v[48:51], v[84:87], v[20:23], v[48:51]
    buffer_load_dwordx4 v[84:87], v3, s[32:35], s72 offen offset:256 nt
    s_waitcnt vmcnt(23)
    v_mfma_f32_16x16x32_bf16 v[52:55], v[88:91], v[16:19], 0
    buffer_load_dwordx4 v[88:91], v3, s[32:35], s72 offen offset:2048 nt
    buffer_load_dwordx4 v[168:171], v4, s[40:43], s73 offen offset:1792
    s_waitcnt vmcnt(23)
    v_mfma_f32_16x16x32_bf16 v[52:55], v[92:95], v[20:23], v[52:55]
    buffer_load_dwordx4 v[92:95], v3, s[32:35], s72 offen offset:2304 nt
    v_mov_b32_dpp v8, v32 quad_perm:[0,0,0,0] row_mask:0xf bank_mask:0xf
    v_mov_b32_dpp v9, v36 quad_perm:[0,0,0,0] row_mask:0xf bank_mask:0xf
    v_mov_b32_dpp v10, v40 quad_perm:[0,0,0,0] row_mask:0xf bank_mask:0xf
    v_mov_b32_dpp v11, v44 quad_perm:[0,0,0,0] row_mask:0xf bank_mask:0xf
    v_add_f32_dpp v8, v33, v8 quad_perm:[1,1,1,1] row_mask:0xf bank_mask:0xf
    v_add_f32_dpp v9, v37, v9 quad_perm:[1,1,1,1] row_mask:0xf bank_mask:0xf
    v_add_f32_dpp v10, v41, v10 quad_perm:[1,1,1,1] row_mask:0xf bank_mask:0xf
    v_add_f32_dpp v11, v45, v11 quad_perm:[1,1,1,1] row_mask:0xf bank_mask:0xf
    v_add_f32_dpp v8, v34, v8 quad_perm:[2,2,2,2] row_mask:0xf bank_mask:0xf
    v_add_f32_dpp v9, v38, v9 quad_perm:[2,2,2,2] row_mask:0xf bank_mask:0xf
    v_add_f32_dpp v10, v42, v10 quad_perm:[2,2,2,2] row_mask:0xf bank_mask:0xf
    v_add_f32_dpp v11, v46, v11 quad_perm:[2,2,2,2] row_mask:0xf bank_mask:0xf
    v_add_f32_dpp v30, v35, v8 quad_perm:[3,3,3,3] row_mask:0xf bank_mask:0x1
    s_nop 1
    v_add_f32_dpp v30, v39, v9 quad_perm:[3,3,3,3] row_mask:0xf bank_mask:0x2
    s_nop 1
    v_add_f32_dpp v30, v43, v10 quad_perm:[3,3,3,3] row_mask:0xf bank_mask:0x4
    s_nop 1
    v_add_f32_dpp v30, v47, v11 quad_perm:[3,3,3,3] row_mask:0xf bank_mask:0x8
    s_waitcnt vmcnt(23)
    v_mfma_f32_16x16x32_bf16 v[56:59], v[96:99], v[16:19], 0
    s_mov_b32 s72, 98304
    buffer_load_dwordx4 v[96:99], v3, s[32:35], s72 offen offset:0 nt
    buffer_load_dwordx4 v[172:175], v4, s[40:43], s73 offen offset:2688
    s_waitcnt vmcnt(23)
    v_mfma_f32_16x16x32_bf16 v[56:59], v[100:103], v[20:23], v[56:59]
    buffer_load_dwordx4 v[100:103], v3, s[32:35], s72 offen offset:256 nt
    s_waitcnt vmcnt(23)
    v_mfma_f32_16x16x32_bf16 v[60:63], v[104:107], v[16:19], 0
    buffer_load_dwordx4 v[104:107], v3, s[32:35], s72 offen offset:2048 nt
    s_mov_b32 s73, 60928
    buffer_load_dwordx4 v[176:179], v4, s[40:43], s73 offen offset:0
    s_waitcnt vmcnt(23)
    v_mfma_f32_16x16x32_bf16 v[60:63], v[108:111], v[20:23], v[60:63]
    buffer_load_dwordx4 v[108:111], v3, s[32:35], s72 offen offset:2304 nt
    v_mov_b32_dpp v8, v48 quad_perm:[0,0,0,0] row_mask:0xf bank_mask:0xf
    v_mov_b32_dpp v9, v52 quad_perm:[0,0,0,0] row_mask:0xf bank_mask:0xf
    v_mov_b32_dpp v10, v56 quad_perm:[0,0,0,0] row_mask:0xf bank_mask:0xf
    s_nop 3
    v_mov_b32_dpp v11, v60 quad_perm:[0,0,0,0] row_mask:0xf bank_mask:0xf
    v_add_f32_dpp v8, v49, v8 quad_perm:[1,1,1,1] row_mask:0xf bank_mask:0xf
    v_add_f32_dpp v9, v53, v9 quad_perm:[1,1,1,1] row_mask:0xf bank_mask:0xf
    v_add_f32_dpp v10, v57, v10 quad_perm:[1,1,1,1] row_mask:0xf bank_mask:0xf
    v_add_f32_dpp v11, v61, v11 quad_perm:[1,1,1,1] row_mask:0xf bank_mask:0xf
    v_add_f32_dpp v8, v50, v8 quad_perm:[2,2,2,2] row_mask:0xf bank_mask:0xf
    v_add_f32_dpp v9, v54, v9 quad_perm:[2,2,2,2] row_mask:0xf bank_mask:0xf
    v_add_f32_dpp v10, v58, v10 quad_perm:[2,2,2,2] row_mask:0xf bank_mask:0xf
    v_add_f32_dpp v11, v62, v11 quad_perm:[2,2,2,2] row_mask:0xf bank_mask:0xf
    v_add_f32_dpp v31, v51, v8 quad_perm:[3,3,3,3] row_mask:0xf bank_mask:0x1
    s_nop 1
    v_add_f32_dpp v31, v55, v9 quad_perm:[3,3,3,3] row_mask:0xf bank_mask:0x2
    s_nop 1
    v_add_f32_dpp v31, v59, v10 quad_perm:[3,3,3,3] row_mask:0xf bank_mask:0x4
    s_nop 1
    v_add_f32_dpp v31, v63, v11 quad_perm:[3,3,3,3] row_mask:0xf bank_mask:0x8
    v_cvt_pk_bf16_f32 v8, v24, v25
    v_cvt_pk_bf16_f32 v9, v26, v27
    v_cvt_pk_bf16_f32 v10, v28, v29
    v_cvt_pk_bf16_f32 v11, v30, v31
    v_lshlrev_b32 v24, 16, v8
    v_and_b32 v25, 0xffff0000, v8
    v_lshlrev_b32 v26, 16, v9
    v_and_b32 v27, 0xffff0000, v9
    v_lshlrev_b32 v28, 16, v10
    v_and_b32 v29, 0xffff0000, v10
    v_lshlrev_b32 v30, 16, v11
    v_and_b32 v31, 0xffff0000, v11
    v_max3_f32 v48, v24, v25, v26
    v_max3_f32 v50, v27, v28, v29
    v_max3_f32 v48, v48, v30, v31
    v_max_f32 v48, v48, v50
    s_nop 1
    v_max_f32_dpp v48, v48, v48 row_ror:4 row_mask:0xf bank_mask:0xf
    s_nop 1
    v_max_f32_dpp v48, v48, v48 row_ror:8 row_mask:0xf bank_mask:0xf
    v_mov_b32 v50, v48
    s_nop 1
    v_permlane16_swap_b32 v48, v50
    v_max_f32 v48, v48, v50
    v_mov_b32 v50, v48
    s_nop 1
    v_permlane32_swap_b32 v48, v50
    v_max_f32 v48, v48, v50
    v_mul_f32 v50, s78, v48
    v_fma_f32 v24, v24, s78, -v50
    v_fma_f32 v25, v25, s78, -v50
    v_fma_f32 v26, v26, s78, -v50
    v_fma_f32 v27, v27, s78, -v50
    v_fma_f32 v28, v28, s78, -v50
    v_fma_f32 v29, v29, s78, -v50
    v_fma_f32 v30, v30, s78, -v50
    v_fma_f32 v31, v31, s78, -v50
    v_exp_f32 v24, v24
    v_exp_f32 v25, v25
    v_exp_f32 v26, v26
    v_exp_f32 v27, v27
    v_exp_f32 v28, v28
    v_exp_f32 v29, v29
    v_exp_f32 v30, v30
    v_exp_f32 v31, v31
    v_add_f32 v49, v24, v25
    v_add_f32 v50, v26, v27
    v_add_f32 v49, v49, v28
    v_add_f32 v50, v50, v29
    v_add_f32 v49, v49, v30
    v_add_f32 v50, v50, v31
    v_add_f32 v49, v49, v50
    v_cvt_pk_bf16_f32 v24, v24, v24
    v_cvt_pk_bf16_f32 v25, v25, v25
    v_cvt_pk_bf16_f32 v26, v26, v26
    v_cvt_pk_bf16_f32 v27, v27, v27
    v_cvt_pk_bf16_f32 v28, v28, v28
    v_cvt_pk_bf16_f32 v29, v29, v29
    v_cvt_pk_bf16_f32 v30, v30, v30
    v_cvt_pk_bf16_f32 v31, v31, v31
    v_and_b32_dpp v32, v24, v12 row_newbcast:0 row_mask:0xf bank_mask:0xf
    v_and_b32_dpp v33, v24, v13 row_newbcast:0 row_mask:0xf bank_mask:0xf
    v_and_b32_dpp v34, v24, v14 row_newbcast:0 row_mask:0xf bank_mask:0xf
    v_and_b32_dpp v35, v24, v15 row_newbcast:0 row_mask:0xf bank_mask:0xf
    v_add_f32_dpp v49, v49, v49 row_ror:4 row_mask:0xf bank_mask:0xf
    s_nop 1
    v_add_f32_dpp v49, v49, v49 row_ror:8 row_mask:0xf bank_mask:0xf
    v_mov_b32 v50, v49
    s_nop 1
    v_permlane16_swap_b32 v49, v50
    v_add_f32 v49, v49, v50
    v_mov_b32 v50, v49
    s_nop 1
    v_permlane32_swap_b32 v49, v50
    v_add_f32 v49, v49, v50
    v_mov_b32 v60, v48
    v_lshrrev_b32 v50, 4, v0
    v_and_b32 v50, 28, v50
    v_add_u32 v50, 15488, v50
    s_mov_b64 exec, 1
    ds_write2_b32 v50, v48, v49 offset0:0 offset1:8
    s_mov_b64 exec, -1
    s_waitcnt vmcnt(23)
    v_mfma_f32_16x16x32_bf16 v[40:43], v[32:35], v[112:115], 0
    s_setprio 1
    s_mov_b32 s72, 131072
    buffer_load_dwordx4 v[112:115], v3, s[32:35], s72 offen offset:0 nt
    buffer_load_dwordx4 v[180:183], v4, s[40:43], s73 offen offset:896
    s_waitcnt vmcnt(23)
    v_mfma_f32_16x16x32_bf16 v[44:47], v[32:35], v[116:119], 0
    buffer_load_dwordx4 v[116:119], v3, s[32:35], s72 offen offset:256 nt
    v_and_b32_dpp v36, v24, v12 row_newbcast:4 row_mask:0xf bank_mask:0xf
    v_and_b32_dpp v37, v24, v13 row_newbcast:4 row_mask:0xf bank_mask:0xf
    v_and_b32_dpp v38, v24, v14 row_newbcast:4 row_mask:0xf bank_mask:0xf
    v_and_b32_dpp v39, v24, v15 row_newbcast:4 row_mask:0xf bank_mask:0xf
    s_waitcnt vmcnt(23)
    s_nop 0
    v_mfma_f32_16x16x32_bf16 v[40:43], v[36:39], v[120:123], v[40:43]
    buffer_load_dwordx4 v[120:123], v3, s[32:35], s72 offen offset:2048 nt
    buffer_load_dwordx4 v[184:187], v4, s[40:43], s73 offen offset:1792
    s_waitcnt vmcnt(23)
    v_mfma_f32_16x16x32_bf16 v[44:47], v[36:39], v[124:127], v[44:47]
    buffer_load_dwordx4 v[124:127], v3, s[32:35], s72 offen offset:2304 nt
    v_and_b32_dpp v32, v24, v12 row_newbcast:8 row_mask:0xf bank_mask:0xf
    v_and_b32_dpp v33, v24, v13 row_newbcast:8 row_mask:0xf bank_mask:0xf
    v_and_b32_dpp v34, v24, v14 row_newbcast:8 row_mask:0xf bank_mask:0xf
    v_and_b32_dpp v35, v24, v15 row_newbcast:8 row_mask:0xf bank_mask:0xf
    s_waitcnt vmcnt(23)
    s_nop 0
    v_mfma_f32_16x16x32_bf16 v[40:43], v[32:35], v[64:67], v[40:43]
    s_mov_b32 s72, 163840
    buffer_load_dwordx4 v[64:67], v3, s[32:35], s72 offen offset:0 nt
    buffer_load_dwordx4 v[188:191], v4, s[40:43], s73 offen offset:2688
    s_waitcnt vmcnt(23)
    v_mfma_f32_16x16x32_bf16 v[44:47], v[32:35], v[68:71], v[44:47]
    buffer_load_dwordx4 v[68:71], v3, s[32:35], s72 offen offset:256 nt
    v_and_b32_dpp v36, v24, v12 row_newbcast:12 row_mask:0xf bank_mask:0xf
    v_and_b32_dpp v37, v24, v13 row_newbcast:12 row_mask:0xf bank_mask:0xf
    v_and_b32_dpp v38, v24, v14 row_newbcast:12 row_mask:0xf bank_mask:0xf
    v_and_b32_dpp v39, v24, v15 row_newbcast:12 row_mask:0xf bank_mask:0xf
    s_waitcnt vmcnt(23)
    s_nop 0
    v_mfma_f32_16x16x32_bf16 v[40:43], v[36:39], v[72:75], v[40:43]
    buffer_load_dwordx4 v[72:75], v3, s[32:35], s72 offen offset:2048 nt
    s_mov_b32 s73, 114688
    buffer_load_dwordx4 v[192:195], v4, s[40:43], s73 offen offset:0
    v_perm_b32 v8, v132, v128, s80
    v_perm_b32 v132, v132, v128, s81
    v_mov_b32 v128, v8
    v_perm_b32 v8, v133, v129, s80
    v_perm_b32 v9, v133, v129, s81
    v_perm_b32 v129, v140, v136, s80
    v_perm_b32 v133, v140, v136, s81
    v_mov_b32 v136, v8
    v_mov_b32 v140, v9
    v_perm_b32 v8, v134, v130, s80
    v_perm_b32 v9, v134, v130, s81
    v_perm_b32 v130, v148, v144, s80
    v_perm_b32 v134, v148, v144, s81
    v_mov_b32 v144, v8
    v_mov_b32 v148, v9
    v_perm_b32 v8, v135, v131, s80
    v_perm_b32 v9, v135, v131, s81
    v_perm_b32 v131, v156, v152, s80
    v_perm_b32 v135, v156, v152, s81
    v_mov_b32 v152, v8
    v_mov_b32 v156, v9
    v_perm_b32 v8, v141, v137, s80
    v_perm_b32 v141, v141, v137, s81
    v_mov_b32 v137, v8
    v_perm_b32 v8, v142, v138, s80
    v_perm_b32 v9, v142, v138, s81
    v_perm_b32 v138, v149, v145, s80
    v_perm_b32 v142, v149, v145, s81
    v_mov_b32 v145, v8
    v_mov_b32 v149, v9
    v_perm_b32 v8, v143, v139, s80
    v_perm_b32 v9, v143, v139, s81
    v_perm_b32 v139, v157, v153, s80
    v_perm_b32 v143, v157, v153, s81
    v_mov_b32 v153, v8
    v_mov_b32 v157, v9
    v_perm_b32 v8, v150, v146, s80
    v_perm_b32 v150, v150, v146, s81
    v_mov_b32 v146, v8
    v_perm_b32 v8, v151, v147, s80
    v_perm_b32 v9, v151, v147, s81
    v_perm_b32 v147, v158, v154, s80
    v_perm_b32 v151, v158, v154, s81
    v_mov_b32 v154, v8
    v_mov_b32 v158, v9
    v_perm_b32 v8, v159, v155, s80
    v_perm_b32 v159, v159, v155, s81
    v_mov_b32 v155, v8
    s_waitcnt vmcnt(23)
    v_mfma_f32_16x16x32_bf16 v[44:47], v[36:39], v[76:79], v[44:47]
    buffer_load_dwordx4 v[76:79], v3, s[32:35], s72 offen offset:2304 nt
    v_and_b32_dpp v32, v25, v12 row_newbcast:0 row_mask:0xf bank_mask:0xf
    v_and_b32_dpp v33, v25, v13 row_newbcast:0 row_mask:0xf bank_mask:0xf
    v_and_b32_dpp v34, v25, v14 row_newbcast:0 row_mask:0xf bank_mask:0xf
    v_and_b32_dpp v35, v25, v15 row_newbcast:0 row_mask:0xf bank_mask:0xf
    s_waitcnt vmcnt(23)
    s_nop 0
    v_mfma_f32_16x16x32_bf16 v[40:43], v[32:35], v[80:83], v[40:43]
    s_mov_b32 s72, 196608
    buffer_load_dwordx4 v[80:83], v3, s[32:35], s72 offen offset:0 nt
    buffer_load_dwordx4 v[196:199], v4, s[40:43], s73 offen offset:896
    s_waitcnt vmcnt(23)
    v_mfma_f32_16x16x32_bf16 v[44:47], v[32:35], v[84:87], v[44:47]
    buffer_load_dwordx4 v[84:87], v3, s[32:35], s72 offen offset:256 nt
    v_and_b32_dpp v36, v25, v12 row_newbcast:4 row_mask:0xf bank_mask:0xf
    v_and_b32_dpp v37, v25, v13 row_newbcast:4 row_mask:0xf bank_mask:0xf
    v_and_b32_dpp v38, v25, v14 row_newbcast:4 row_mask:0xf bank_mask:0xf
    v_and_b32_dpp v39, v25, v15 row_newbcast:4 row_mask:0xf bank_mask:0xf
    s_waitcnt vmcnt(23)
    s_nop 0
    v_mfma_f32_16x16x32_bf16 v[40:43], v[36:39], v[88:91], v[40:43]
    buffer_load_dwordx4 v[88:91], v3, s[32:35], s72 offen offset:2048 nt
    buffer_load_dwordx4 v[200:203], v4, s[40:43], s73 offen offset:1792
    s_waitcnt vmcnt(23)
    v_mfma_f32_16x16x32_bf16 v[44:47], v[36:39], v[92:95], v[44:47]
    buffer_load_dwordx4 v[92:95], v3, s[32:35], s72 offen offset:2304 nt
    v_and_b32_dpp v32, v25, v12 row_newbcast:8 row_mask:0xf bank_mask:0xf
    v_and_b32_dpp v33, v25, v13 row_newbcast:8 row_mask:0xf bank_mask:0xf
    v_and_b32_dpp v34, v25, v14 row_newbcast:8 row_mask:0xf bank_mask:0xf
    v_and_b32_dpp v35, v25, v15 row_newbcast:8 row_mask:0xf bank_mask:0xf
    s_waitcnt vmcnt(23)
    s_nop 0
    v_mfma_f32_16x16x32_bf16 v[40:43], v[32:35], v[96:99], v[40:43]
    s_mov_b32 s72, 229376
    buffer_load_dwordx4 v[96:99], v3, s[32:35], s72 offen offset:0 nt
    buffer_load_dwordx4 v[204:207], v4, s[40:43], s73 offen offset:2688
    s_waitcnt vmcnt(23)
    v_mfma_f32_16x16x32_bf16 v[44:47], v[32:35], v[100:103], v[44:47]
    buffer_load_dwordx4 v[100:103], v3, s[32:35], s72 offen offset:256 nt
    v_and_b32_dpp v36, v25, v12 row_newbcast:12 row_mask:0xf bank_mask:0xf
    v_and_b32_dpp v37, v25, v13 row_newbcast:12 row_mask:0xf bank_mask:0xf
    v_and_b32_dpp v38, v25, v14 row_newbcast:12 row_mask:0xf bank_mask:0xf
    v_and_b32_dpp v39, v25, v15 row_newbcast:12 row_mask:0xf bank_mask:0xf
    s_waitcnt vmcnt(23)
    s_nop 0
    v_mfma_f32_16x16x32_bf16 v[40:43], v[36:39], v[104:107], v[40:43]
    buffer_load_dwordx4 v[104:107], v3, s[32:35], s72 offen offset:2048 nt
    s_mov_b32 s73, 118272
    buffer_load_dwordx4 v[208:211], v4, s[40:43], s73 offen offset:0
    s_waitcnt vmcnt(23)
    v_mfma_f32_16x16x32_bf16 v[44:47], v[36:39], v[108:111], v[44:47]
    buffer_load_dwordx4 v[108:111], v3, s[32:35], s72 offen offset:2304 nt
    v_and_b32_dpp v32, v26, v12 row_newbcast:0 row_mask:0xf bank_mask:0xf
    v_and_b32_dpp v33, v26, v13 row_newbcast:0 row_mask:0xf bank_mask:0xf
    v_and_b32_dpp v34, v26, v14 row_newbcast:0 row_mask:0xf bank_mask:0xf
    v_and_b32_dpp v35, v26, v15 row_newbcast:0 row_mask:0xf bank_mask:0xf
    s_waitcnt vmcnt(23)
    s_nop 0
    v_mfma_f32_16x16x32_bf16 v[40:43], v[32:35], v[112:115], v[40:43]
    s_mov_b32 s72, 262144
    buffer_load_dwordx4 v[112:115], v3, s[32:35], s72 offen offset:0 nt
    buffer_load_dwordx4 v[212:215], v4, s[40:43], s73 offen offset:896
    s_waitcnt vmcnt(23)
    v_mfma_f32_16x16x32_bf16 v[44:47], v[32:35], v[116:119], v[44:47]
    buffer_load_dwordx4 v[116:119], v3, s[32:35], s72 offen offset:2048 nt
    v_and_b32_dpp v36, v26, v12 row_newbcast:4 row_mask:0xf bank_mask:0xf
    v_and_b32_dpp v37, v26, v13 row_newbcast:4 row_mask:0xf bank_mask:0xf
    v_and_b32_dpp v38, v26, v14 row_newbcast:4 row_mask:0xf bank_mask:0xf
    v_and_b32_dpp v39, v26, v15 row_newbcast:4 row_mask:0xf bank_mask:0xf
    s_waitcnt vmcnt(23)
    s_nop 0
    v_mfma_f32_16x16x32_bf16 v[40:43], v[36:39], v[120:123], v[40:43]
    s_mov_b32 s72, 294912
    buffer_load_dwordx4 v[120:123], v3, s[32:35], s72 offen offset:0 nt
    buffer_load_dwordx4 v[216:219], v4, s[40:43], s73 offen offset:1792
    s_waitcnt vmcnt(23)
    v_mfma_f32_16x16x32_bf16 v[44:47], v[36:39], v[124:127], v[44:47]
    buffer_load_dwordx4 v[124:127], v3, s[32:35], s72 offen offset:2048 nt
    v_and_b32_dpp v32, v26, v12 row_newbcast:8 row_mask:0xf bank_mask:0xf
    v_and_b32_dpp v33, v26, v13 row_newbcast:8 row_mask:0xf bank_mask:0xf
    v_and_b32_dpp v34, v26, v14 row_newbcast:8 row_mask:0xf bank_mask:0xf
    v_and_b32_dpp v35, v26, v15 row_newbcast:8 row_mask:0xf bank_mask:0xf
    s_waitcnt vmcnt(23)
    s_nop 0
    v_mfma_f32_16x16x32_bf16 v[40:43], v[32:35], v[64:67], v[40:43]
    s_mov_b32 s72, 327680
    buffer_load_dwordx4 v[64:67], v3, s[32:35], s72 offen offset:0 nt
    buffer_load_dwordx4 v[220:223], v4, s[40:43], s73 offen offset:2688
    v_mov_b32 v7, 0
    global_load_dwordx4 v[16:19], v7, s[24:25] sc1
    s_waitcnt vmcnt(24)
    v_mfma_f32_16x16x32_bf16 v[44:47], v[32:35], v[68:71], v[44:47]
    buffer_load_dwordx4 v[68:71], v3, s[32:35], s72 offen offset:2048 nt
    v_and_b32_dpp v36, v26, v12 row_newbcast:12 row_mask:0xf bank_mask:0xf
    v_and_b32_dpp v37, v26, v13 row_newbcast:12 row_mask:0xf bank_mask:0xf
    v_and_b32_dpp v38, v26, v14 row_newbcast:12 row_mask:0xf bank_mask:0xf
    v_and_b32_dpp v39, v26, v15 row_newbcast:12 row_mask:0xf bank_mask:0xf
    s_waitcnt vmcnt(24)
    s_nop 0
    v_mfma_f32_16x16x32_bf16 v[40:43], v[36:39], v[72:75], v[40:43]
    s_mov_b32 s72, 360448
    buffer_load_dwordx4 v[72:75], v3, s[32:35], s72 offen offset:0 nt
    s_mov_b32 s73, 172032
    buffer_load_dwordx4 v[224:227], v4, s[40:43], s73 offen offset:0
    v_perm_b32 v8, v164, v160, s80
    v_perm_b32 v164, v164, v160, s81
    v_mov_b32 v160, v8
    v_perm_b32 v8, v165, v161, s80
    v_perm_b32 v9, v165, v161, s81
    v_perm_b32 v161, v172, v168, s80
    v_perm_b32 v165, v172, v168, s81
    v_mov_b32 v168, v8
    v_mov_b32 v172, v9
    v_perm_b32 v8, v166, v162, s80
    v_perm_b32 v9, v166, v162, s81
    v_perm_b32 v162, v180, v176, s80
    v_perm_b32 v166, v180, v176, s81
    v_mov_b32 v176, v8
    v_mov_b32 v180, v9
    v_perm_b32 v8, v167, v163, s80
    v_perm_b32 v9, v167, v163, s81
    v_perm_b32 v163, v188, v184, s80
    v_perm_b32 v167, v188, v184, s81
    v_mov_b32 v184, v8
    v_mov_b32 v188, v9
    v_perm_b32 v8, v173, v169, s80
    v_perm_b32 v173, v173, v169, s81
    v_mov_b32 v169, v8
    v_perm_b32 v8, v174, v170, s80
    v_perm_b32 v9, v174, v170, s81
    v_perm_b32 v170, v181, v177, s80
    v_perm_b32 v174, v181, v177, s81
    v_mov_b32 v177, v8
    v_mov_b32 v181, v9
    v_perm_b32 v8, v175, v171, s80
    v_perm_b32 v9, v175, v171, s81
    v_perm_b32 v171, v189, v185, s80
    v_perm_b32 v175, v189, v185, s81
    v_mov_b32 v185, v8
    v_mov_b32 v189, v9
    v_perm_b32 v8, v182, v178, s80
    v_perm_b32 v182, v182, v178, s81
    v_mov_b32 v178, v8
    v_perm_b32 v8, v183, v179, s80
    v_perm_b32 v9, v183, v179, s81
    v_perm_b32 v179, v190, v186, s80
    v_perm_b32 v183, v190, v186, s81
    v_mov_b32 v186, v8
    v_mov_b32 v190, v9
    v_perm_b32 v8, v191, v187, s80
    v_perm_b32 v191, v191, v187, s81
    v_mov_b32 v187, v8
    s_waitcnt vmcnt(24)
    v_mfma_f32_16x16x32_bf16 v[44:47], v[36:39], v[76:79], v[44:47]
    buffer_load_dwordx4 v[76:79], v3, s[32:35], s72 offen offset:2048 nt
    v_and_b32_dpp v32, v27, v12 row_newbcast:0 row_mask:0xf bank_mask:0xf
    v_and_b32_dpp v33, v27, v13 row_newbcast:0 row_mask:0xf bank_mask:0xf
    v_and_b32_dpp v34, v27, v14 row_newbcast:0 row_mask:0xf bank_mask:0xf
    v_and_b32_dpp v35, v27, v15 row_newbcast:0 row_mask:0xf bank_mask:0xf
    s_waitcnt vmcnt(24)
    s_nop 0
    v_mfma_f32_16x16x32_bf16 v[40:43], v[32:35], v[80:83], v[40:43]
    s_mov_b32 s72, 393216
    buffer_load_dwordx4 v[80:83], v3, s[32:35], s72 offen offset:0 nt
    buffer_load_dwordx4 v[228:231], v4, s[40:43], s73 offen offset:896
    s_waitcnt vmcnt(24)
    v_mfma_f32_16x16x32_bf16 v[44:47], v[32:35], v[84:87], v[44:47]
    buffer_load_dwordx4 v[84:87], v3, s[32:35], s72 offen offset:2048 nt
    v_and_b32_dpp v36, v27, v12 row_newbcast:4 row_mask:0xf bank_mask:0xf
    v_and_b32_dpp v37, v27, v13 row_newbcast:4 row_mask:0xf bank_mask:0xf
    v_and_b32_dpp v38, v27, v14 row_newbcast:4 row_mask:0xf bank_mask:0xf
    v_and_b32_dpp v39, v27, v15 row_newbcast:4 row_mask:0xf bank_mask:0xf
    s_waitcnt vmcnt(24)
    s_nop 0
    v_mfma_f32_16x16x32_bf16 v[40:43], v[36:39], v[88:91], v[40:43]
    s_mov_b32 s72, 425984
    buffer_load_dwordx4 v[88:91], v3, s[32:35], s72 offen offset:0 nt
    buffer_load_dwordx4 v[232:235], v4, s[40:43], s73 offen offset:1792
    s_cmp_eq_u32 s68, 7
    s_nop 3
    s_cbranch_scc0 L_nopf
    s_getpc_b64 s[74:75]
L_pc:
    s_add_u32 s74, s74, L_tail-L_pc
    s_addc_u32 s75, s75, 0
    v_lshlrev_b32 v8, 4, v1
    global_load_dwordx4 v[128:131], v8, s[74:75] offset:0
    global_load_dwordx4 v[132:135], v8, s[74:75] offset:1024
    global_load_dwordx4 v[136:139], v8, s[74:75] offset:2048
    global_load_dwordx4 v[140:143], v8, s[74:75] offset:3072
L_nopf:
    s_waitcnt vmcnt(24)
    v_mfma_f32_16x16x32_bf16 v[44:47], v[36:39], v[92:95], v[44:47]
    buffer_load_dwordx4 v[92:95], v3, s[32:35], s72 offen offset:2048 nt
    v_and_b32_dpp v32, v27, v12 row_newbcast:8 row_mask:0xf bank_mask:0xf
    v_and_b32_dpp v33, v27, v13 row_newbcast:8 row_mask:0xf bank_mask:0xf
    v_and_b32_dpp v34, v27, v14 row_newbcast:8 row_mask:0xf bank_mask:0xf
    v_and_b32_dpp v35, v27, v15 row_newbcast:8 row_mask:0xf bank_mask:0xf
    s_waitcnt vmcnt(24)
    s_nop 0
    v_mfma_f32_16x16x32_bf16 v[40:43], v[32:35], v[96:99], v[40:43]
    s_mov_b32 s72, 458752
    buffer_load_dwordx4 v[96:99], v3, s[32:35], s72 offen offset:0 nt
    buffer_load_dwordx4 v[236:239], v4, s[40:43], s73 offen offset:2688
    s_cmp_eq_u32 s68, 7
    s_cbranch_scc0 L_noffpf
    s_lshr_b32 s77, s2, 3
    s_getreg_b32 s76, hwreg(HW_REG_XCC_ID, 0, 3)
    s_mul_i32 s74, s77, 50176
    s_mul_i32 s75, s76, 448
    s_add_u32 s74, s74, s75
    v_lshrrev_b32 v144, 2, v1
    v_mul_u32_u24 v145, 3584, v144
    v_and_b32 v144, 3, v0
    v_lshlrev_b32 v144, 7, v144
    v_min_u32 v144, 444, v144
    v_add3_u32 v145, v145, v144, s74
    s_mul_i32 s74, s77, 6272
    s_mul_i32 s75, s76, 200704
    s_add_u32 s74, s74, s75
    v_min_u32 v144, 48, v1
    v_lshl_add_u32 v144, v144, 7, s74
    s_mov_b32 exec_hi, 0xffffff
    global_load_dword v128, v145, s[16:17]
    global_load_dword v129, v145, s[18:19]
    global_load_dword v130, v144, s[20:21]
L_nodpf:
    s_mov_b32 exec_hi, -1
L_noffpf:
    s_waitcnt vmcnt(24)
    v_mfma_f32_16x16x32_bf16 v[44:47], v[32:35], v[100:103], v[44:47]
    buffer_load_dwordx4 v[100:103], v3, s[32:35], s72 offen offset:2048 nt
    v_and_b32_dpp v36, v27, v12 row_newbcast:12 row_mask:0xf bank_mask:0xf
    v_and_b32_dpp v37, v27, v13 row_newbcast:12 row_mask:0xf bank_mask:0xf
    v_and_b32_dpp v38, v27, v14 row_newbcast:12 row_mask:0xf bank_mask:0xf
    v_and_b32_dpp v39, v27, v15 row_newbcast:12 row_mask:0xf bank_mask:0xf
    s_waitcnt vmcnt(24)
    s_nop 0
    v_mfma_f32_16x16x32_bf16 v[40:43], v[36:39], v[104:107], v[40:43]
    s_mov_b32 s72, 491520
    buffer_load_dwordx4 v[104:107], v3, s[32:35], s72 offen offset:0 nt
    s_mov_b32 s73, 175616
    buffer_load_dwordx4 v[240:243], v4, s[40:43], s73 offen offset:0
    s_waitcnt vmcnt(24)
    v_mfma_f32_16x16x32_bf16 v[44:47], v[36:39], v[108:111], v[44:47]
    buffer_load_dwordx4 v[108:111], v3, s[32:35], s72 offen offset:2048 nt
    v_and_b32_dpp v32, v28, v12 row_newbcast:0 row_mask:0xf bank_mask:0xf
    v_and_b32_dpp v33, v28, v13 row_newbcast:0 row_mask:0xf bank_mask:0xf
    v_and_b32_dpp v34, v28, v14 row_newbcast:0 row_mask:0xf bank_mask:0xf
    v_and_b32_dpp v35, v28, v15 row_newbcast:0 row_mask:0xf bank_mask:0xf
    s_waitcnt vmcnt(24)
    s_nop 0
    v_mfma_f32_16x16x32_bf16 v[40:43], v[32:35], v[112:115], v[40:43]
    s_setprio 0
    s_mov_b32 s72, 262144
    buffer_load_dwordx4 v[112:115], v3, s[32:35], s72 offen offset:256 nt
    buffer_load_dwordx4 v[244:247], v4, s[40:43], s73 offen offset:896
    v_and_b32_dpp v36, v28, v12 row_newbcast:4 row_mask:0xf bank_mask:0xf
    v_and_b32_dpp v37, v28, v13 row_newbcast:4 row_mask:0xf bank_mask:0xf
    v_and_b32_dpp v38, v28, v14 row_newbcast:4 row_mask:0xf bank_mask:0xf
    v_and_b32_dpp v39, v28, v15 row_newbcast:4 row_mask:0xf bank_mask:0xf
    s_waitcnt vmcnt(24)
    s_nop 0
    v_mfma_f32_16x16x32_bf16 v[40:43], v[36:39], v[116:119], v[40:43]
    buffer_load_dwordx4 v[116:119], v3, s[32:35], s72 offen offset:2304 nt
    v_and_b32_dpp v32, v28, v12 row_newbcast:8 row_mask:0xf bank_mask:0xf
    v_and_b32_dpp v33, v28, v13 row_newbcast:8 row_mask:0xf bank_mask:0xf
    v_and_b32_dpp v34, v28, v14 row_newbcast:8 row_mask:0xf bank_mask:0xf
    v_and_b32_dpp v35, v28, v15 row_newbcast:8 row_mask:0xf bank_mask:0xf
    s_waitcnt vmcnt(24)
    s_nop 0
    v_mfma_f32_16x16x32_bf16 v[40:43], v[32:35], v[120:123], v[40:43]
    s_mov_b32 s72, 294912
    buffer_load_dwordx4 v[120:123], v3, s[32:35], s72 offen offset:256 nt
    buffer_load_dwordx4 v[248:251], v4, s[40:43], s73 offen offset:1792
    v_and_b32_dpp v36, v28, v12 row_newbcast:12 row_mask:0xf bank_mask:0xf
    v_and_b32_dpp v37, v28, v13 row_newbcast:12 row_mask:0xf bank_mask:0xf
    v_and_b32_dpp v38, v28, v14 row_newbcast:12 row_mask:0xf bank_mask:0xf
    v_and_b32_dpp v39, v28, v15 row_newbcast:12 row_mask:0xf bank_mask:0xf
    s_waitcnt vmcnt(24)
    s_nop 0
    v_mfma_f32_16x16x32_bf16 v[40:43], v[36:39], v[124:127], v[40:43]
    buffer_load_dwordx4 v[124:127], v3, s[32:35], s72 offen offset:2304 nt
    v_and_b32_dpp v32, v29, v12 row_newbcast:0 row_mask:0xf bank_mask:0xf
    v_and_b32_dpp v33, v29, v13 row_newbcast:0 row_mask:0xf bank_mask:0xf
    v_and_b32_dpp v34, v29, v14 row_newbcast:0 row_mask:0xf bank_mask:0xf
    v_and_b32_dpp v35, v29, v15 row_newbcast:0 row_mask:0xf bank_mask:0xf
    s_waitcnt vmcnt(24)
    s_nop 0
    v_mfma_f32_16x16x32_bf16 v[40:43], v[32:35], v[64:67], v[40:43]
    s_mov_b32 s72, 327680
    buffer_load_dwordx4 v[64:67], v3, s[32:35], s72 offen offset:256 nt
    buffer_load_dwordx4 v[252:255], v4, s[40:43], s73 offen offset:2688
    v_and_b32_dpp v36, v29, v12 row_newbcast:4 row_mask:0xf bank_mask:0xf
    v_and_b32_dpp v37, v29, v13 row_newbcast:4 row_mask:0xf bank_mask:0xf
    v_and_b32_dpp v38, v29, v14 row_newbcast:4 row_mask:0xf bank_mask:0xf
    v_and_b32_dpp v39, v29, v15 row_newbcast:4 row_mask:0xf bank_mask:0xf
    s_waitcnt vmcnt(23)
    s_nop 0
    v_mfma_f32_16x16x32_bf16 v[40:43], v[36:39], v[68:71], v[40:43]
    buffer_load_dwordx4 v[68:71], v3, s[32:35], s72 offen offset:2304 nt
    s_mov_b32 s82, 131072
    s_nop 5
L_cc0:
    v_readfirstlane_b32 s0, v16
    v_readfirstlane_b32 s1, v17
    s_and_b32 s74, s0, s1
    s_and_b32 s74, s74, 0x80808080
    s_cmp_eq_u32 s74, 0x80808080
    s_cbranch_scc1 L_cc0_ok
    v_mov_b32 v7, 0
    global_load_dwordx4 v[16:19], v7, s[24:25] sc1
    s_sub_u32 s82, s82, 1
    s_waitcnt vmcnt(0)
    s_cbranch_scc0 L_cc0
L_cc0_ok:
    s_bfe_u32 s74, s0, 0x30004
    s_add_u32 s74, s74, s2
    s_and_b32 s74, s74, 7
    s_andn2_b32 s2, s2, 7
    s_or_b32 s2, s2, s74
    v_readfirstlane_b32 s28, v18
    v_readfirstlane_b32 s30, v19
    v_and_b32 v16, 1, v0
    v_cmp_eq_u32 vcc, 0, v16
    s_nop 1
    v_cndmask_b32 v18, v19, v18, vcc
    s_mov_b32 s100, 0xfff
    s_not_b32 s101, s100
    s_lshr_b32 s29, s28, 16
    s_and_b32 s28, s28, 0xffff
    s_lshr_b32 s31, s30, 16
    s_and_b32 s30, s30, 0xffff
    v_and_b32 v63, 0xffff, v18
    v_lshrrev_b32 v4, 16, v18
    s_and_b32 s0, s0, 0x0f0f0f0f
    s_and_b32 s1, s1, 0x0f0f0f0f
    s_add_u32 s0, s0, s1
    s_mul_i32 s0, s0, 0x01010101
    s_lshr_b32 s0, s0, 24
    s_cmp_gt_u32 s0, 64
    s_cselect_b32 s1, 0x2000, 0
    s_and_b32 s73, s69, 1
    s_lshl_b32 s73, s73, 4
    s_add_u32 s73, s73, s70
    s_lshl_b32 s73, s73, 14
    s_lshr_b32 s74, s69, 1
    s_lshl_b32 s74, s74, 13
    s_xor_b32 s74, s74, s1
    s_add_u32 s73, s73, s74
    s_and_b32 s74, s71, 3
    s_mul_i32 s75, s74, 1792
    s_lshl_b32 s74, s74, 3
    s_add_u32 s74, s74, 7168
    s_cmp_eq_u32 s68, 7
    s_cselect_b32 s74, s74, s75
    s_add_u32 s73, s73, s74
    v_and_b32_dpp v32, v29, v12 row_newbcast:8 row_mask:0xf bank_mask:0xf
    v_and_b32_dpp v33, v29, v13 row_newbcast:8 row_mask:0xf bank_mask:0xf
    v_and_b32_dpp v34, v29, v14 row_newbcast:8 row_mask:0xf bank_mask:0xf
    v_and_b32_dpp v35, v29, v15 row_newbcast:8 row_mask:0xf bank_mask:0xf
    s_waitcnt vmcnt(23)
    s_nop 0
    v_mfma_f32_16x16x32_bf16 v[40:43], v[32:35], v[72:75], v[40:43]
    s_mov_b32 s72, 360448
    buffer_load_dwordx4 v[72:75], v3, s[32:35], s72 offen offset:256 nt
    v_perm_b32 v8, v196, v192, s80
    v_perm_b32 v196, v196, v192, s81
    v_mov_b32 v192, v8
    v_perm_b32 v8, v197, v193, s80
    v_perm_b32 v9, v197, v193, s81
    v_perm_b32 v193, v204, v200, s80
    v_perm_b32 v197, v204, v200, s81
    v_mov_b32 v200, v8
    v_mov_b32 v204, v9
    v_perm_b32 v8, v198, v194, s80
    v_perm_b32 v9, v198, v194, s81
    v_perm_b32 v194, v212, v208, s80
    v_perm_b32 v198, v212, v208, s81
    v_mov_b32 v208, v8
    v_mov_b32 v212, v9
    v_perm_b32 v8, v199, v195, s80
    v_perm_b32 v9, v199, v195, s81
    v_perm_b32 v195, v220, v216, s80
    v_perm_b32 v199, v220, v216, s81
    v_mov_b32 v216, v8
    v_mov_b32 v220, v9
    v_perm_b32 v8, v205, v201, s80
    v_perm_b32 v205, v205, v201, s81
    v_mov_b32 v201, v8
    v_perm_b32 v8, v206, v202, s80
    v_perm_b32 v9, v206, v202, s81
    v_perm_b32 v202, v213, v209, s80
    v_perm_b32 v206, v213, v209, s81
    v_mov_b32 v209, v8
    v_mov_b32 v213, v9
    v_perm_b32 v8, v207, v203, s80
    v_perm_b32 v9, v207, v203, s81
    v_perm_b32 v203, v221, v217, s80
    v_perm_b32 v207, v221, v217, s81
    v_mov_b32 v217, v8
    v_mov_b32 v221, v9
    v_perm_b32 v8, v214, v210, s80
    v_perm_b32 v214, v214, v210, s81
    v_mov_b32 v210, v8
    v_perm_b32 v8, v215, v211, s80
    v_perm_b32 v9, v215, v211, s81
    v_perm_b32 v211, v222, v218, s80
    v_perm_b32 v215, v222, v218, s81
    v_mov_b32 v218, v8
    v_mov_b32 v222, v9
    v_perm_b32 v8, v223, v219, s80
    v_perm_b32 v223, v223, v219, s81
    v_mov_b32 v219, v8
    s_mov_b32 s64, s26
    s_mov_b32 s65, s27
    s_mov_b32 s66, 0
    s_mov_b32 s67, 0x20000
    s_cmp_eq_u32 s68, 7
    s_cselect_b32 s66, 0x400000, 0
    v_mov_b32 v61, 1
    v_lshrrev_b32 v62, 4, v0
    s_mov_b64 exec, 1
    s_and_b32 s74, s2, 7
    s_mul_i32 s74, s74, 4352
    s_add_u32 s74, s74, 0x1fff80
    buffer_atomic_add v61, off, s[64:67], s74 offset:128 sc0 sc1
    s_mov_b64 exec, -1
    v_and_b32_dpp v36, v29, v12 row_newbcast:12 row_mask:0xf bank_mask:0xf
    v_and_b32_dpp v37, v29, v13 row_newbcast:12 row_mask:0xf bank_mask:0xf
    v_and_b32_dpp v38, v29, v14 row_newbcast:12 row_mask:0xf bank_mask:0xf
    v_and_b32_dpp v39, v29, v15 row_newbcast:12 row_mask:0xf bank_mask:0xf
    v_lshrrev_b32 v8, 6, v0
    v_mul_u32_u24 v52, 576, v8
    v_and_b32 v8, 64, v0
    v_lshrrev_b32 v8, 1, v8
    v_sub_u32 v52, v52, v8
    v_and_b32 v8, 15, v0
    v_lshl_add_u32 v52, v8, 4, v52
    v_bfe_u32 v9, v0, 4, 2
    v_lshl_add_u32 v52, v9, 3, v52
    v_and_b32 v8, 7, v0
    v_mul_u32_u24 v53, 576, v8
    v_and_b32 v10, 1, v0
    v_lshlrev_b32 v10, 5, v10
    v_sub_u32 v53, v53, v10
    v_and_b32 v10, 8, v0
    v_lshl_add_u32 v53, v10, 3, v53
    v_lshl_add_u32 v53, v9, 4, v53
    v_and_b32 v54, 16, v0
    v_and_b32 v55, 0x1c0, v0
    v_lshl_add_u32 v55, v8, 3, v55
    v_bfe_u32 v10, v0, 5, 1
    v_lshl_add_u32 v55, v10, 2, v55
    v_lshlrev_b32 v55, 2, v55
    v_and_b32 v55, 0x1f0, v0
    v_lshlrev_b32 v55, 2, v55
    v_lshl_add_u32 v55, v8, 3, v55
    s_waitcnt vmcnt(23)
    v_mfma_f32_16x16x32_bf16 v[40:43], v[36:39], v[76:79], v[40:43]
    buffer_load_dwordx4 v[76:79], v3, s[32:35], s72 offen offset:2304 nt
    v_and_b32_dpp v32, v30, v12 row_newbcast:0 row_mask:0xf bank_mask:0xf
    v_and_b32_dpp v33, v30, v13 row_newbcast:0 row_mask:0xf bank_mask:0xf
    v_and_b32_dpp v34, v30, v14 row_newbcast:0 row_mask:0xf bank_mask:0xf
    v_and_b32_dpp v35, v30, v15 row_newbcast:0 row_mask:0xf bank_mask:0xf
    s_mov_b32 s82, 131072
    s_cmp_eq_u32 s68, 7
    s_nop 0
    s_cbranch_scc1 L_psw7
    v_xor_b32 v8, 16, v54
    s_nop 1
L_ps0:
    ds_read_b128 v[16:19], v54 offset:15488
    ds_read_b128 v[20:23], v8 offset:15488
    s_sub_u32 s82, s82, 1
    s_waitcnt lgkmcnt(0)
    v_max3_u32 v9, v16, v17, v18
    v_max3_u32 v10, v20, v21, v22
    v_max3_u32 v9, v9, v19, v23
    v_max_u32 v9, v9, v10
    v_cmp_eq_u32 vcc, -1, v9
    s_cbranch_scc1 L_ps1
    s_cbranch_vccnz L_ps0
L_ps1:
    v_max3_f32 v20, v20, v21, v22
    v_max3_f32 v21, v16, v17, v18
    v_max3_f32 v20, v20, v23, v19
    v_max_f32 v20, v20, v21
    v_mul_f32 v20, s78, v20
    v_fma_f32 v60, v60, s78, -v20
    v_exp_f32 v60, v60
    s_nop 1
    s_branch L_psx
L_psw7:
    v_and_b32 v8, 7, v0
    v_lshlrev_b32 v8, 2, v8
    v_add_u32 v8, 15488, v8
    s_nop 1
L_ps7:
    ds_read2_b32 v[48:49], v8 offset0:0 offset1:8
    s_mov_b32 s74, s73
    s_sub_u32 s82, s82, 1
    s_waitcnt lgkmcnt(0)
    v_max_u32 v50, v48, v49
    v_cmp_eq_u32 vcc, -1, v50
    s_cbranch_scc1 L_ps8
    s_cbranch_vccnz L_ps7
L_ps8:
    v_mov_b32 v8, 0
    s_waitcnt lgkmcnt(0)
    v_mov_b32 v50, v48
    s_nop 1
    v_max_f32_dpp v50, v50, v50 row_ror:1 row_mask:0xf bank_mask:0xf
    s_nop 1
    v_max_f32_dpp v50, v50, v50 row_ror:2 row_mask:0xf bank_mask:0xf
    s_nop 1
    v_max_f32_dpp v50, v50, v50 row_ror:4 row_mask:0xf bank_mask:0xf
    v_sub_f32 v48, v48, v50
    v_mul_f32 v48, s78, v48
    v_exp_f32 v48, v48
    v_sub_f32 v60, v60, v50
    v_mul_f32 v60, s78, v60
    v_exp_f32 v60, v60
    v_mul_f32 v51, v48, v49
    s_nop 1
    v_add_f32_dpp v51, v51, v51 row_ror:1 row_mask:0xf bank_mask:0xf
    s_nop 1
    v_add_f32_dpp v51, v51, v51 row_ror:2 row_mask:0xf bank_mask:0xf
    s_nop 1
    v_add_f32_dpp v51, v51, v51 row_ror:4 row_mask:0xf bank_mask:0xf
    s_mov_b64 exec, 1
    buffer_store_dwordx2 v[50:51], v8, s[48:51], s74 offen sc1
    s_mov_b64 exec, -1
L_psx:
    s_waitcnt vmcnt(23)
    v_mfma_f32_16x16x32_bf16 v[40:43], v[32:35], v[80:83], v[40:43]
    s_mov_b32 s72, 393216
    buffer_load_dwordx4 v[80:83], v3, s[32:35], s72 offen offset:256 nt
    v_and_b32_dpp v36, v30, v12 row_newbcast:4 row_mask:0xf bank_mask:0xf
    v_and_b32_dpp v37, v30, v13 row_newbcast:4 row_mask:0xf bank_mask:0xf
    v_and_b32_dpp v38, v30, v14 row_newbcast:4 row_mask:0xf bank_mask:0xf
    v_and_b32_dpp v39, v30, v15 row_newbcast:4 row_mask:0xf bank_mask:0xf
    s_waitcnt vmcnt(22)
    s_nop 0
    v_mfma_f32_16x16x32_bf16 v[40:43], v[36:39], v[84:87], v[40:43]
    buffer_load_dwordx4 v[84:87], v3, s[32:35], s72 offen offset:2304 nt
    v_and_b32_dpp v32, v30, v12 row_newbcast:8 row_mask:0xf bank_mask:0xf
    v_and_b32_dpp v33, v30, v13 row_newbcast:8 row_mask:0xf bank_mask:0xf
    v_and_b32_dpp v34, v30, v14 row_newbcast:8 row_mask:0xf bank_mask:0xf
    v_and_b32_dpp v35, v30, v15 row_newbcast:8 row_mask:0xf bank_mask:0xf
    s_waitcnt vmcnt(22)
    s_nop 0
    v_mfma_f32_16x16x32_bf16 v[40:43], v[32:35], v[88:91], v[40:43]
    s_mov_b32 s72, 425984
    buffer_load_dwordx4 v[88:91], v3, s[32:35], s72 offen offset:256 nt
    v_and_b32_dpp v36, v30, v12 row_newbcast:12 row_mask:0xf bank_mask:0xf
    v_and_b32_dpp v37, v30, v13 row_newbcast:12 row_mask:0xf bank_mask:0xf
    v_and_b32_dpp v38, v30, v14 row_newbcast:12 row_mask:0xf bank_mask:0xf
    v_and_b32_dpp v39, v30, v15 row_newbcast:12 row_mask:0xf bank_mask:0xf
    s_waitcnt vmcnt(21)
    s_nop 0
    v_mfma_f32_16x16x32_bf16 v[40:43], v[36:39], v[92:95], v[40:43]
    buffer_load_dwordx4 v[92:95], v3, s[32:35], s72 offen offset:2304 nt
    v_and_b32_dpp v32, v31, v12 row_newbcast:0 row_mask:0xf bank_mask:0xf
    v_and_b32_dpp v33, v31, v13 row_newbcast:0 row_mask:0xf bank_mask:0xf
    v_and_b32_dpp v34, v31, v14 row_newbcast:0 row_mask:0xf bank_mask:0xf
    v_and_b32_dpp v35, v31, v15 row_newbcast:0 row_mask:0xf bank_mask:0xf
    s_waitcnt vmcnt(21)
    s_nop 0
    v_mfma_f32_16x16x32_bf16 v[40:43], v[32:35], v[96:99], v[40:43]
    s_mov_b32 s72, 458752
    buffer_load_dwordx4 v[96:99], v3, s[32:35], s72 offen offset:256 nt
    v_and_b32_dpp v36, v31, v12 row_newbcast:4 row_mask:0xf bank_mask:0xf
    v_and_b32_dpp v37, v31, v13 row_newbcast:4 row_mask:0xf bank_mask:0xf
    v_and_b32_dpp v38, v31, v14 row_newbcast:4 row_mask:0xf bank_mask:0xf
    v_and_b32_dpp v39, v31, v15 row_newbcast:4 row_mask:0xf bank_mask:0xf
    s_waitcnt vmcnt(20)
    s_nop 0
    v_mfma_f32_16x16x32_bf16 v[40:43], v[36:39], v[100:103], v[40:43]
    buffer_load_dwordx4 v[100:103], v3, s[32:35], s72 offen offset:2304 nt
    v_and_b32_dpp v32, v31, v12 row_newbcast:8 row_mask:0xf bank_mask:0xf
    v_and_b32_dpp v33, v31, v13 row_newbcast:8 row_mask:0xf bank_mask:0xf
    v_and_b32_dpp v34, v31, v14 row_newbcast:8 row_mask:0xf bank_mask:0xf
    v_and_b32_dpp v35, v31, v15 row_newbcast:8 row_mask:0xf bank_mask:0xf
    s_waitcnt vmcnt(20)
    s_nop 0
    v_mfma_f32_16x16x32_bf16 v[40:43], v[32:35], v[104:107], v[40:43]
    s_mov_b32 s72, 491520
    buffer_load_dwordx4 v[104:107], v3, s[32:35], s72 offen offset:256 nt
    v_and_b32_dpp v36, v31, v12 row_newbcast:12 row_mask:0xf bank_mask:0xf
    v_and_b32_dpp v37, v31, v13 row_newbcast:12 row_mask:0xf bank_mask:0xf
    v_and_b32_dpp v38, v31, v14 row_newbcast:12 row_mask:0xf bank_mask:0xf
    v_and_b32_dpp v39, v31, v15 row_newbcast:12 row_mask:0xf bank_mask:0xf
    s_waitcnt vmcnt(19)
    s_nop 0
    v_mfma_f32_16x16x32_bf16 v[40:43], v[36:39], v[108:111], v[40:43]
    buffer_load_dwordx4 v[108:111], v3, s[32:35], s72 offen offset:2304 nt
    v_and_b32_dpp v32, v28, v12 row_newbcast:0 row_mask:0xf bank_mask:0xf
    v_and_b32_dpp v33, v28, v13 row_newbcast:0 row_mask:0xf bank_mask:0xf
    v_and_b32_dpp v34, v28, v14 row_newbcast:0 row_mask:0xf bank_mask:0xf
    v_and_b32_dpp v35, v28, v15 row_newbcast:0 row_mask:0xf bank_mask:0xf
    s_nop 2
    v_mul_f32 v40, v40, v60
    v_mul_f32 v41, v41, v60
    v_mul_f32 v42, v42, v60
    v_mul_f32 v43, v43, v60
    v_cvt_pk_bf16_f32 v48, v40, v41
    v_cvt_pk_bf16_f32 v49, v42, v43
    s_mov_b32 exec_hi, 0
    ds_write_b64 v52, v[48:49] offset:10752
    s_mov_b32 exec_hi, -1
    s_waitcnt lgkmcnt(0)
    s_barrier
    ds_read_b128 v[48:51], v53 offset:10752
    ds_read_b128 v[56:59], v53 offset:10880
    s_waitcnt vmcnt(19)
    v_mfma_f32_16x16x32_bf16 v[44:47], v[32:35], v[112:115], v[44:47]
    v_and_b32_dpp v36, v28, v12 row_newbcast:4 row_mask:0xf bank_mask:0xf
    v_and_b32_dpp v37, v28, v13 row_newbcast:4 row_mask:0xf bank_mask:0xf
    v_and_b32_dpp v38, v28, v14 row_newbcast:4 row_mask:0xf bank_mask:0xf
    v_and_b32_dpp v39, v28, v15 row_newbcast:4 row_mask:0xf bank_mask:0xf
    s_waitcnt lgkmcnt(1)
    v_mfma_f32_16x16x32_bf16 v[112:115], v[48:51], v[128:131], 0
    s_waitcnt lgkmcnt(0)
    v_mfma_f32_16x16x32_bf16 v[112:115], v[56:59], v[160:163], v[112:115]
    s_waitcnt vmcnt(17)
    v_mfma_f32_16x16x32_bf16 v[44:47], v[36:39], v[116:119], v[44:47]
    v_and_b32_dpp v32, v28, v12 row_newbcast:8 row_mask:0xf bank_mask:0xf
    v_and_b32_dpp v33, v28, v13 row_newbcast:8 row_mask:0xf bank_mask:0xf
    v_and_b32_dpp v34, v28, v14 row_newbcast:8 row_mask:0xf bank_mask:0xf
    v_and_b32_dpp v35, v28, v15 row_newbcast:8 row_mask:0xf bank_mask:0xf
    v_mfma_f32_16x16x32_bf16 v[116:119], v[48:51], v[132:135], 0
    v_mfma_f32_16x16x32_bf16 v[116:119], v[56:59], v[164:167], v[116:119]
    s_waitcnt vmcnt(16)
    v_mfma_f32_16x16x32_bf16 v[44:47], v[32:35], v[120:123], v[44:47]
    v_and_b32_dpp v36, v28, v12 row_newbcast:12 row_mask:0xf bank_mask:0xf
    v_and_b32_dpp v37, v28, v13 row_newbcast:12 row_mask:0xf bank_mask:0xf
    v_and_b32_dpp v38, v28, v14 row_newbcast:12 row_mask:0xf bank_mask:0xf
    v_and_b32_dpp v39, v28, v15 row_newbcast:12 row_mask:0xf bank_mask:0xf
    v_mfma_f32_16x16x32_bf16 v[120:123], v[48:51], v[136:139], 0
    v_mfma_f32_16x16x32_bf16 v[120:123], v[56:59], v[168:171], v[120:123]
    s_waitcnt vmcnt(14)
    v_mfma_f32_16x16x32_bf16 v[44:47], v[36:39], v[124:127], v[44:47]
    v_and_b32_dpp v32, v29, v12 row_newbcast:0 row_mask:0xf bank_mask:0xf
    v_and_b32_dpp v33, v29, v13 row_newbcast:0 row_mask:0xf bank_mask:0xf
    v_and_b32_dpp v34, v29, v14 row_newbcast:0 row_mask:0xf bank_mask:0xf
    v_and_b32_dpp v35, v29, v15 row_newbcast:0 row_mask:0xf bank_mask:0xf
    v_mfma_f32_16x16x32_bf16 v[124:127], v[48:51], v[140:143], 0
    v_mfma_f32_16x16x32_bf16 v[124:127], v[56:59], v[172:175], v[124:127]
    s_waitcnt vmcnt(13)
    v_mfma_f32_16x16x32_bf16 v[44:47], v[32:35], v[64:67], v[44:47]
    v_and_b32_dpp v36, v29, v12 row_newbcast:4 row_mask:0xf bank_mask:0xf
    v_and_b32_dpp v37, v29, v13 row_newbcast:4 row_mask:0xf bank_mask:0xf
    v_and_b32_dpp v38, v29, v14 row_newbcast:4 row_mask:0xf bank_mask:0xf
    v_and_b32_dpp v39, v29, v15 row_newbcast:4 row_mask:0xf bank_mask:0xf
    v_mfma_f32_16x16x32_bf16 v[64:67], v[48:51], v[144:147], 0
    v_mfma_f32_16x16x32_bf16 v[64:67], v[56:59], v[176:179], v[64:67]
    s_waitcnt vmcnt(11)
    v_mfma_f32_16x16x32_bf16 v[44:47], v[36:39], v[68:71], v[44:47]
    v_and_b32_dpp v32, v29, v12 row_newbcast:8 row_mask:0xf bank_mask:0xf
    v_and_b32_dpp v33, v29, v13 row_newbcast:8 row_mask:0xf bank_mask:0xf
    v_and_b32_dpp v34, v29, v14 row_newbcast:8 row_mask:0xf bank_mask:0xf
    v_and_b32_dpp v35, v29, v15 row_newbcast:8 row_mask:0xf bank_mask:0xf
    v_mfma_f32_16x16x32_bf16 v[68:71], v[48:51], v[148:151], 0
    v_mfma_f32_16x16x32_bf16 v[68:71], v[56:59], v[180:183], v[68:71]
    s_waitcnt vmcnt(10)
    v_mfma_f32_16x16x32_bf16 v[44:47], v[32:35], v[72:75], v[44:47]
    v_perm_b32 v8, v228, v224, s80
    v_perm_b32 v228, v228, v224, s81
    v_mov_b32 v224, v8
    v_perm_b32 v8, v229, v225, s80
    v_perm_b32 v9, v229, v225, s81
    v_perm_b32 v225, v236, v232, s80
    v_perm_b32 v229, v236, v232, s81
    v_mov_b32 v232, v8
    v_mov_b32 v236, v9
    v_perm_b32 v8, v230, v226, s80
    v_perm_b32 v9, v230, v226, s81
    v_perm_b32 v226, v244, v240, s80
    v_perm_b32 v230, v244, v240, s81
    v_mov_b32 v240, v8
    v_mov_b32 v244, v9
    v_perm_b32 v8, v231, v227, s80
    v_perm_b32 v9, v231, v227, s81
    v_perm_b32 v227, v252, v248, s80
    v_perm_b32 v231, v252, v248, s81
    v_mov_b32 v248, v8
    v_mov_b32 v252, v9
    v_perm_b32 v8, v237, v233, s80
    v_perm_b32 v237, v237, v233, s81
    v_mov_b32 v233, v8
    v_perm_b32 v8, v238, v234, s80
    v_perm_b32 v9, v238, v234, s81
    v_perm_b32 v234, v245, v241, s80
    v_perm_b32 v238, v245, v241, s81
    v_mov_b32 v241, v8
    v_mov_b32 v245, v9
    v_perm_b32 v8, v239, v235, s80
    v_perm_b32 v9, v239, v235, s81
    v_perm_b32 v235, v253, v249, s80
    v_perm_b32 v239, v253, v249, s81
    v_mov_b32 v249, v8
    v_mov_b32 v253, v9
    v_perm_b32 v8, v246, v242, s80
    v_perm_b32 v246, v246, v242, s81
    v_mov_b32 v242, v8
    v_perm_b32 v8, v247, v243, s80
    v_perm_b32 v9, v247, v243, s81
    v_perm_b32 v243, v254, v250, s80
    v_perm_b32 v247, v254, v250, s81
    v_mov_b32 v250, v8
    v_mov_b32 v254, v9
    v_perm_b32 v8, v255, v251, s80
    v_perm_b32 v255, v255, v251, s81
    v_mov_b32 v251, v8
    v_and_b32_dpp v36, v29, v12 row_newbcast:12 row_mask:0xf bank_mask:0xf
    v_and_b32_dpp v37, v29, v13 row_newbcast:12 row_mask:0xf bank_mask:0xf
    v_and_b32_dpp v38, v29, v14 row_newbcast:12 row_mask:0xf bank_mask:0xf
    v_and_b32_dpp v39, v29, v15 row_newbcast:12 row_mask:0xf bank_mask:0xf
    v_mfma_f32_16x16x32_bf16 v[72:75], v[48:51], v[152:155], 0
    v_mfma_f32_16x16x32_bf16 v[72:75], v[56:59], v[184:187], v[72:75]
    s_waitcnt vmcnt(8)
    v_mfma_f32_16x16x32_bf16 v[44:47], v[36:39], v[76:79], v[44:47]
    s_mov_b64 exec, 1
    ds_write_b32 v62, v61 offset:15552
    s_mov_b64 exec, -1
    v_and_b32_dpp v32, v30, v12 row_newbcast:0 row_mask:0xf bank_mask:0xf
    v_and_b32_dpp v33, v30, v13 row_newbcast:0 row_mask:0xf bank_mask:0xf
    v_and_b32_dpp v34, v30, v14 row_newbcast:0 row_mask:0xf bank_mask:0xf
    v_and_b32_dpp v35, v30, v15 row_newbcast:0 row_mask:0xf bank_mask:0xf
    v_mfma_f32_16x16x32_bf16 v[76:79], v[48:51], v[156:159], 0
    v_mfma_f32_16x16x32_bf16 v[76:79], v[56:59], v[188:191], v[76:79]
    s_mov_b32 s82, 131072
    s_cmp_eq_u32 s68, 7
    s_waitcnt lgkmcnt(0)
    s_cbranch_scc1 L_e1x
L_tkp:
    ds_read_b32 v61, v54 offset:15580
    s_sub_u32 s82, s82, 1
    s_waitcnt lgkmcnt(0)
    v_readfirstlane_b32 s79, v61
    s_cbranch_scc1 L_tkq
    s_cmp_eq_u32 s79, -1
    s_cbranch_scc1 L_tkp
L_tkq:
    s_and_b32 s79, s79, 31
    s_cmp_ge_u32 s79, 7
    s_cbranch_scc1 L_e1x
    s_and_b32 s74, s2, 7
    s_mul_i32 s74, s74, 7
    s_add_u32 s79, s79, s74
    s_max_i32 s76, s79, 0
    s_lshl_b32 s74, s76, 6
    s_add_u32 s52, s16, s74
    s_addc_u32 s53, s17, 0
    s_mov_b32 s54, 0
    s_mov_b32 s55, 0x20000
    s_add_u32 s56, s18, s74
    s_addc_u32 s57, s19, 0
    s_mov_b32 s58, 0
    s_mov_b32 s59, 0x20000
    s_sub_u32 s74, 1605632, s74
    s_mul_i32 s75, s76, 28672
    s_add_u32 s60, s20, s75
    s_addc_u32 s61, s21, 0
    s_mov_b32 s62, 0
    s_mov_b32 s63, 0x20000
    s_cmp_eq_u32 s68, 7
    s_cselect_b32 s76, -1, s79
    s_cmp_eq_u32 s76, -1
    s_cselect_b32 s54, 0, s74
    s_cselect_b32 s58, 0, s74
    s_cselect_b32 s62, 0, 28672
    v_bfe_u32 v5, v0, 2, 1
    v_bfe_u32 v8, v0, 4, 2
    v_lshl_add_u32 v5, v8, 1, v5
    v_and_b32 v8, 8, v0
    v_add_u32 v5, v5, v8
    v_and_b32 v8, 0x1c0, v0
    v_add_u32 v5, v5, v8
    v_mul_u32_u24 v5, 3584, v5
    v_and_b32 v9, 3, v0
    v_lshl_add_u32 v5, v9, 4, v5
    v_and_b32 v9, 8, v0
    v_lshlrev_b32 v9, 1, v9
    v_xor_b32 v5, v9, v5
    v_lshlrev_b32 v6, 4, v1
    v_lshl_add_u32 v6, v8, 6, v6
    s_lshl_b32 s3, s68, 12
    s_add_u32 m0, s3, 16384
    s_mov_b32 s76, 0
    buffer_load_dwordx4 v5, s[52:55], s76 offen offset:0 lds
    s_mov_b32 s76, 56320
    buffer_load_dwordx4 v5, s[52:55], s76 offen offset:1024 lds
    s_mov_b32 s76, 112640
    v_xor_b32 v10, 16, v5
    buffer_load_dwordx4 v10, s[52:55], s76 offen offset:2048 lds
    s_mov_b32 s76, 168960
    v_xor_b32 v11, 16, v5
    buffer_load_dwordx4 v11, s[52:55], s76 offen offset:3072 lds
    s_add_u32 m0, s3, 49152
    s_mov_b32 s76, 0
    v_xor_b32 v10, 32, v5
    buffer_load_dwordx4 v10, s[56:59], s76 offen offset:0 lds
    s_mov_b32 s76, 56320
    v_xor_b32 v11, 32, v5
    buffer_load_dwordx4 v11, s[56:59], s76 offen offset:1024 lds
    s_mov_b32 s76, 112640
    v_xor_b32 v10, 48, v5
    buffer_load_dwordx4 v10, s[56:59], s76 offen offset:2048 lds
    s_mov_b32 s76, 168960
    v_xor_b32 v11, 48, v5
    buffer_load_dwordx4 v11, s[56:59], s76 offen offset:3072 lds
    s_add_u32 m0, s3, 81920
    s_mul_i32 s74, s68, 148
    s_add_u32 s74, s74, 0
    s_bfe_u32 s75, s74, 0x10008
    s_lshl_b32 s75, s75, 4
    s_lshr_b32 s74, s74, 2
    s_and_b32 s74, s74, 128
    s_or_b32 s74, s74, s75
    v_xor_b32 v10, s74, v6
    buffer_load_dwordx4 v10, s[60:63], 0 offen offset:0 lds
    s_mul_i32 s74, s68, 148
    s_add_u32 s74, s74, 37
    s_bfe_u32 s75, s74, 0x10008
    s_lshl_b32 s75, s75, 4
    s_lshr_b32 s74, s74, 2
    s_and_b32 s74, s74, 128
    s_or_b32 s74, s74, s75
    v_xor_b32 v11, s74, v6
    buffer_load_dwordx4 v11, s[60:63], 0 offen offset:1024 lds
    s_mul_i32 s74, s68, 148
    s_add_u32 s74, s74, 74
    s_bfe_u32 s75, s74, 0x10008
    s_lshl_b32 s75, s75, 4
    s_lshr_b32 s74, s74, 2
    s_and_b32 s74, s74, 128
    s_or_b32 s74, s74, s75
    v_xor_b32 v10, s74, v6
    buffer_load_dwordx4 v10, s[60:63], 0 offen offset:2048 lds
    s_mul_i32 s74, s68, 148
    s_add_u32 s74, s74, 111
    s_bfe_u32 s75, s74, 0x10008
    s_lshl_b32 s75, s75, 4
    s_lshr_b32 s74, s74, 2
    s_and_b32 s74, s74, 128
    s_or_b32 s74, s74, s75
    v_xor_b32 v11, s74, v6
    buffer_load_dwordx4 v11, s[60:63], 0 offen offset:3072 lds
    s_waitcnt vmcnt(19)
    v_mfma_f32_16x16x32_bf16 v[44:47], v[32:35], v[80:83], v[44:47]
    v_and_b32_dpp v36, v30, v12 row_newbcast:4 row_mask:0xf bank_mask:0xf
    v_and_b32_dpp v37, v30, v13 row_newbcast:4 row_mask:0xf bank_mask:0xf
    v_and_b32_dpp v38, v30, v14 row_newbcast:4 row_mask:0xf bank_mask:0xf
    v_and_b32_dpp v39, v30, v15 row_newbcast:4 row_mask:0xf bank_mask:0xf
    s_waitcnt vmcnt(18)
    s_nop 0
    v_mfma_f32_16x16x32_bf16 v[44:47], v[36:39], v[84:87], v[44:47]
    v_and_b32_dpp v32, v30, v12 row_newbcast:8 row_mask:0xf bank_mask:0xf
    v_and_b32_dpp v33, v30, v13 row_newbcast:8 row_mask:0xf bank_mask:0xf
    v_and_b32_dpp v34, v30, v14 row_newbcast:8 row_mask:0xf bank_mask:0xf
    v_and_b32_dpp v35, v30, v15 row_newbcast:8 row_mask:0xf bank_mask:0xf
    s_waitcnt vmcnt(17)
    s_nop 0
    v_mfma_f32_16x16x32_bf16 v[44:47], v[32:35], v[88:91], v[44:47]
    v_and_b32_dpp v36, v30, v12 row_newbcast:12 row_mask:0xf bank_mask:0xf
    v_and_b32_dpp v37, v30, v13 row_newbcast:12 row_mask:0xf bank_mask:0xf
    v_and_b32_dpp v38, v30, v14 row_newbcast:12 row_mask:0xf bank_mask:0xf
    v_and_b32_dpp v39, v30, v15 row_newbcast:12 row_mask:0xf bank_mask:0xf
    s_waitcnt vmcnt(16)
    s_nop 0
    v_mfma_f32_16x16x32_bf16 v[44:47], v[36:39], v[92:95], v[44:47]
    v_and_b32_dpp v32, v31, v12 row_newbcast:0 row_mask:0xf bank_mask:0xf
    v_and_b32_dpp v33, v31, v13 row_newbcast:0 row_mask:0xf bank_mask:0xf
    v_and_b32_dpp v34, v31, v14 row_newbcast:0 row_mask:0xf bank_mask:0xf
    v_and_b32_dpp v35, v31, v15 row_newbcast:0 row_mask:0xf bank_mask:0xf
    s_waitcnt vmcnt(15)
    s_nop 0
    v_mfma_f32_16x16x32_bf16 v[44:47], v[32:35], v[96:99], v[44:47]
    v_and_b32_dpp v36, v31, v12 row_newbcast:4 row_mask:0xf bank_mask:0xf
    v_and_b32_dpp v37, v31, v13 row_newbcast:4 row_mask:0xf bank_mask:0xf
    v_and_b32_dpp v38, v31, v14 row_newbcast:4 row_mask:0xf bank_mask:0xf
    v_and_b32_dpp v39, v31, v15 row_newbcast:4 row_mask:0xf bank_mask:0xf
    s_waitcnt vmcnt(14)
    s_nop 0
    v_mfma_f32_16x16x32_bf16 v[44:47], v[36:39], v[100:103], v[44:47]
    v_and_b32_dpp v32, v31, v12 row_newbcast:8 row_mask:0xf bank_mask:0xf
    v_and_b32_dpp v33, v31, v13 row_newbcast:8 row_mask:0xf bank_mask:0xf
    v_and_b32_dpp v34, v31, v14 row_newbcast:8 row_mask:0xf bank_mask:0xf
    v_and_b32_dpp v35, v31, v15 row_newbcast:8 row_mask:0xf bank_mask:0xf
    s_waitcnt vmcnt(13)
    s_nop 0
    v_mfma_f32_16x16x32_bf16 v[44:47], v[32:35], v[104:107], v[44:47]
    v_and_b32_dpp v36, v31, v12 row_newbcast:12 row_mask:0xf bank_mask:0xf
    v_and_b32_dpp v37, v31, v13 row_newbcast:12 row_mask:0xf bank_mask:0xf
    v_and_b32_dpp v38, v31, v14 row_newbcast:12 row_mask:0xf bank_mask:0xf
    v_and_b32_dpp v39, v31, v15 row_newbcast:12 row_mask:0xf bank_mask:0xf
    s_waitcnt vmcnt(12)
    s_nop 0
    v_mfma_f32_16x16x32_bf16 v[44:47], v[36:39], v[108:111], v[44:47]
    s_nop 7
    s_branch L_tail
.p2align 6
    s_nop 3
L_e1x:
    s_waitcnt vmcnt(7)
    v_mfma_f32_16x16x32_bf16 v[44:47], v[32:35], v[80:83], v[44:47]
    v_and_b32_dpp v36, v30, v12 row_newbcast:4 row_mask:0xf bank_mask:0xf
    v_and_b32_dpp v37, v30, v13 row_newbcast:4 row_mask:0xf bank_mask:0xf
    v_and_b32_dpp v38, v30, v14 row_newbcast:4 row_mask:0xf bank_mask:0xf
    v_and_b32_dpp v39, v30, v15 row_newbcast:4 row_mask:0xf bank_mask:0xf
    s_waitcnt vmcnt(6)
    s_nop 0
    v_mfma_f32_16x16x32_bf16 v[44:47], v[36:39], v[84:87], v[44:47]
    v_and_b32_dpp v32, v30, v12 row_newbcast:8 row_mask:0xf bank_mask:0xf
    v_and_b32_dpp v33, v30, v13 row_newbcast:8 row_mask:0xf bank_mask:0xf
    v_and_b32_dpp v34, v30, v14 row_newbcast:8 row_mask:0xf bank_mask:0xf
    v_and_b32_dpp v35, v30, v15 row_newbcast:8 row_mask:0xf bank_mask:0xf
    s_waitcnt vmcnt(5)
    s_nop 0
    v_mfma_f32_16x16x32_bf16 v[44:47], v[32:35], v[88:91], v[44:47]
    v_and_b32_dpp v36, v30, v12 row_newbcast:12 row_mask:0xf bank_mask:0xf
    v_and_b32_dpp v37, v30, v13 row_newbcast:12 row_mask:0xf bank_mask:0xf
    v_and_b32_dpp v38, v30, v14 row_newbcast:12 row_mask:0xf bank_mask:0xf
    v_and_b32_dpp v39, v30, v15 row_newbcast:12 row_mask:0xf bank_mask:0xf
    s_waitcnt vmcnt(4)
    s_nop 0
    v_mfma_f32_16x16x32_bf16 v[44:47], v[36:39], v[92:95], v[44:47]
    v_and_b32_dpp v32, v31, v12 row_newbcast:0 row_mask:0xf bank_mask:0xf
    v_and_b32_dpp v33, v31, v13 row_newbcast:0 row_mask:0xf bank_mask:0xf
    v_and_b32_dpp v34, v31, v14 row_newbcast:0 row_mask:0xf bank_mask:0xf
    v_and_b32_dpp v35, v31, v15 row_newbcast:0 row_mask:0xf bank_mask:0xf
    s_waitcnt vmcnt(3)
    s_nop 0
    v_mfma_f32_16x16x32_bf16 v[44:47], v[32:35], v[96:99], v[44:47]
    v_and_b32_dpp v36, v31, v12 row_newbcast:4 row_mask:0xf bank_mask:0xf
    v_and_b32_dpp v37, v31, v13 row_newbcast:4 row_mask:0xf bank_mask:0xf
    v_and_b32_dpp v38, v31, v14 row_newbcast:4 row_mask:0xf bank_mask:0xf
    v_and_b32_dpp v39, v31, v15 row_newbcast:4 row_mask:0xf bank_mask:0xf
    s_waitcnt vmcnt(2)
    s_nop 0
    v_mfma_f32_16x16x32_bf16 v[44:47], v[36:39], v[100:103], v[44:47]
    v_and_b32_dpp v32, v31, v12 row_newbcast:8 row_mask:0xf bank_mask:0xf
    v_and_b32_dpp v33, v31, v13 row_newbcast:8 row_mask:0xf bank_mask:0xf
    v_and_b32_dpp v34, v31, v14 row_newbcast:8 row_mask:0xf bank_mask:0xf
    v_and_b32_dpp v35, v31, v15 row_newbcast:8 row_mask:0xf bank_mask:0xf
    s_waitcnt vmcnt(1)
    s_nop 0
    v_mfma_f32_16x16x32_bf16 v[44:47], v[32:35], v[104:107], v[44:47]
    v_and_b32_dpp v36, v31, v12 row_newbcast:12 row_mask:0xf bank_mask:0xf
    v_and_b32_dpp v37, v31, v13 row_newbcast:12 row_mask:0xf bank_mask:0xf
    v_and_b32_dpp v38, v31, v14 row_newbcast:12 row_mask:0xf bank_mask:0xf
    v_and_b32_dpp v39, v31, v15 row_newbcast:12 row_mask:0xf bank_mask:0xf
    s_waitcnt vmcnt(0)
    s_nop 0
    v_mfma_f32_16x16x32_bf16 v[44:47], v[36:39], v[108:111], v[44:47]
L_tail:
    s_nop 7
    v_pk_mul_f32 v[44:45], v[44:45], v[60:61] op_sel_hi:[1,0]
    v_pk_mul_f32 v[46:47], v[46:47], v[60:61] op_sel_hi:[1,0]
    v_cvt_pk_bf16_f32 v50, v44, v45
    v_cvt_pk_bf16_f32 v51, v46, v47
    s_mov_b32 exec_hi, 0
    ds_write_b64 v52, v[50:51] offset:11008
    s_mov_b64 exec, -1
    s_mov_b32 s72, s73
    s_cmp_eq_u32 s68, 7
    s_waitcnt lgkmcnt(0)
    s_barrier
    s_cbranch_scc1 L_w7tail
    ds_read_b128 v[48:51], v53 offset:11008
    ds_read_b128 v[56:59], v53 offset:11136
    s_waitcnt lgkmcnt(1)
    v_mfma_f32_16x16x32_bf16 v[112:115], v[48:51], v[192:195], v[112:115]
    v_mfma_f32_16x16x32_bf16 v[64:67], v[48:51], v[208:211], v[64:67]
    v_mfma_f32_16x16x32_bf16 v[120:123], v[48:51], v[200:203], v[120:123]
    v_mfma_f32_16x16x32_bf16 v[72:75], v[48:51], v[216:219], v[72:75]
    s_waitcnt lgkmcnt(0)
    v_mfma_f32_16x16x32_bf16 v[112:115], v[56:59], v[224:227], v[112:115]
    v_mfma_f32_16x16x32_bf16 v[64:67], v[56:59], v[240:243], v[64:67]
    v_mfma_f32_16x16x32_bf16 v[120:123], v[56:59], v[232:235], v[120:123]
    v_mfma_f32_16x16x32_bf16 v[72:75], v[56:59], v[248:251], v[72:75]
    v_mfma_f32_16x16x32_bf16 v[116:119], v[48:51], v[196:199], v[116:119]
    v_mfma_f32_16x16x32_bf16 v[68:71], v[48:51], v[212:215], v[68:71]
    v_mfma_f32_16x16x32_bf16 v[124:127], v[48:51], v[204:207], v[124:127]
    v_mfma_f32_16x16x32_bf16 v[76:79], v[48:51], v[220:223], v[76:79]
    v_mfma_f32_16x16x32_bf16 v[116:119], v[56:59], v[228:231], v[116:119]
    v_mfma_f32_16x16x32_bf16 v[68:71], v[56:59], v[244:247], v[68:71]
    v_mfma_f32_16x16x32_bf16 v[124:127], v[56:59], v[236:239], v[124:127]
    v_mfma_f32_16x16x32_bf16 v[76:79], v[56:59], v[252:255], v[76:79]
    v_add_f32 v112, v112, v114
    v_add_f32 v113, v113, v115
    v_add_f32 v64, v64, v66
    v_add_f32 v65, v65, v67
    v_add_f32 v120, v120, v122
    v_add_f32 v121, v121, v123
    v_add_f32 v72, v72, v74
    v_add_f32 v73, v73, v75
    v_add_f32 v112, v112, v113
    v_add_f32 v64, v64, v65
    v_add_f32 v120, v120, v121
    v_add_f32 v72, v72, v73
    v_add_f32 v116, v116, v118
    v_add_f32 v117, v117, v119
    v_permlane32_swap_b32 v112, v64
    v_permlane32_swap_b32 v120, v72
    v_add_f32 v68, v68, v70
    v_add_f32 v69, v69, v71
    v_add_f32 v124, v124, v126
    v_add_f32 v125, v125, v127
    v_add_f32_dpp v112, v64, v112 row_ror:8 row_mask:0xf bank_mask:0xf
    v_add_f32_dpp v120, v72, v120 row_ror:8 row_mask:0xf bank_mask:0xf
    v_add_f32 v76, v76, v78
    v_add_f32 v77, v77, v79
    v_add_f32 v116, v116, v117
    v_add_f32 v68, v68, v69
    v_permlane16_swap_b32 v112, v120
    v_add_f32 v124, v124, v125
    v_add_f32 v76, v76, v77
    v_add_f32 v80, v112, v120
    v_permlane32_swap_b32 v116, v68
    v_permlane32_swap_b32 v124, v76
    v_bfi_b32 v80, s100, v63, v80
    v_add_f32_dpp v116, v68, v116 row_ror:8 row_mask:0xf bank_mask:0xf
    v_add_f32_dpp v124, v76, v124 row_ror:8 row_mask:0xf bank_mask:0xf
    s_nop 1
    v_permlane16_swap_b32 v116, v124
    v_add_f32 v81, v116, v124
    s_waitcnt lgkmcnt(0)
    s_mov_b32 exec_lo, 0x00ff00ff
    s_mov_b32 exec_hi, 0x00ff00ff
    v_bfi_b32 v81, s100, v4, v81
    buffer_store_dwordx2 v[80:81], v55, s[48:51], s72 offen sc1
    s_mov_b64 exec, -1
    v_readfirstlane_b32 s79, v61
    s_and_b32 s79, s79, 31
    s_cmp_ge_u32 s79, 7
    s_nop 2
    s_cbranch_scc1 L_fin
    s_and_b32 s74, s2, 7
    s_mul_i32 s74, s74, 7
    s_add_u32 s79, s79, s74
    s_waitcnt vmcnt(1)
    s_barrier
    v_and_b32 v9, 48, v0
    v_lshrrev_b32 v9, 1, v9
    v_mul_u32_u24 v8, 896, v9
    v_and_b32 v10, 3, v0
    v_lshl_add_u32 v8, v10, 5, v8
    v_and_b32 v56, 12, v0
    v_add_u32 v8, v56, v8
    v_and_b32 v11, 0x1c0, v0
    v_lshl_add_u32 v8, v11, 1, v8
    v_add_u32 v8, 81920, v8
    v_and_b32 v60, 32, v0
    v_lshlrev_b32 v60, 2, v60
    v_and_or_b32 v60, v0, 16, v60
    v_add_u32 v59, 896, v8
    v_xor_b32 v8, v60, v8
    v_xor_b32 v59, v60, v59
    v_xor_b32 v58, 16, v8
    v_xor_b32 v60, 16, v59
    ds_read_b32 v64, v8 offset:0
    ds_read_b32 v65, v58 offset:0
    ds_read_b32 v66, v59 offset:0
    ds_read_b32 v67, v60 offset:0
    ds_read_b32 v68, v8 offset:1792
    ds_read_b32 v69, v58 offset:1792
    ds_read_b32 v70, v59 offset:1792
    ds_read_b32 v71, v60 offset:1792
    ds_read_b32 v72, v8 offset:3584
    ds_read_b32 v73, v58 offset:3584
    ds_read_b32 v74, v59 offset:3584
    ds_read_b32 v75, v60 offset:3584
    s_waitcnt lgkmcnt(8)
    ds_read_b32 v76, v8 offset:5376
    ds_read_b32 v77, v58 offset:5376
    ds_read_b32 v78, v59 offset:5376
    ds_read_b32 v79, v60 offset:5376
    v_lshlrev_b32 v56, 4, v56
    v_lshl_add_u32 v56, v9, 1, v56
    v_bfe_u32 v57, v0, 4, 1
    v_mul_u32_u24 v57, 1792, v57
    v_and_b32 v8, 32, v0
    v_lshl_add_u32 v57, v8, 8, v57
    v_xor_b32 v57, s1, v57
    v_lshl_add_u32 v57, v11, 2, v57
    v_and_b32 v8, 15, v0
    v_lshl_add_u32 v57, v8, 4, v57
    s_lshr_b32 s72, s79, 1
    s_lshl_b32 s72, s72, 14
    s_and_b32 s74, s79, 1
    s_lshl_b32 s74, s74, 12
    s_add_u32 s72, s72, s74
    s_add_u32 s72, s72, 0xa0000
    v_mov_b32 v62, s100
    s_waitcnt lgkmcnt(0)
    v_perm_b32 v128, v66, v64, s80
    v_perm_b32 v129, v70, v68, s80
    v_perm_b32 v130, v74, v72, s80
    v_perm_b32 v131, v78, v76, s80
    v_perm_b32 v132, v66, v64, s81
    v_perm_b32 v133, v70, v68, s81
    v_perm_b32 v134, v74, v72, s81
    v_perm_b32 v135, v78, v76, s81
    v_perm_b32 v136, v67, v65, s80
    v_perm_b32 v137, v71, v69, s80
    v_perm_b32 v138, v75, v73, s80
    v_perm_b32 v139, v79, v77, s80
    v_perm_b32 v140, v67, v65, s81
    v_perm_b32 v141, v71, v69, s81
    v_perm_b32 v142, v75, v73, s81
    v_perm_b32 v143, v79, v77, s81
    v_mov_b32 v64, 0
    v_mov_b32 v65, 0
    v_mov_b32 v66, 0
    v_mov_b32 v67, 0
    v_mov_b32 v68, 0
    v_mov_b32 v69, 0
    v_mov_b32 v70, 0
    v_mov_b32 v71, 0
    v_mov_b32 v72, 0
    v_mov_b32 v73, 0
    v_mov_b32 v74, 0
    v_mov_b32 v75, 0
    v_mov_b32 v76, 0
    v_mov_b32 v77, 0
    v_mov_b32 v78, 0
    v_mov_b32 v79, 0
    s_cmp_ge_u32 s68, 4
    s_waitcnt lgkmcnt(0)
    s_cbranch_scc1 L_ffn2
    v_and_b32 v10, 2, v0
    v_mul_u32_u24 v8, 16400, v10
    v_and_b32 v10, 8, v0
    v_mad_u32_u24 v8, v10, 18, v8
    v_and_b32 v10, 4, v0
    v_lshl_add_u32 v8, v10, 4, v8
    v_and_b32 v10, 32, v0
    v_lshl_add_u32 v8, v10, 3, v8
    v_and_b32 v10, 1, v0
    v_lshl_add_u32 v8, v10, 3, v8
    v_and_b32 v10, 16, v0
    v_lshl_add_u32 v8, v10, 7, v8
    v_xor_b32 v8, v10, v8
    v_lshrrev_b32 v11, 2, v11
    v_xor_b32 v8, v8, v11
    ds_read_b64_tr_b16 v[144:145], v8 offset:16384
    ds_read_b64_tr_b16 v[146:147], v8 offset:17408
    ds_read_b64_tr_b16 v[148:149], v8 offset:16896
    ds_read_b64_tr_b16 v[150:151], v8 offset:17920
    ds_read_b64_tr_b16 v[152:153], v8 offset:20480
    ds_read_b64_tr_b16 v[154:155], v8 offset:21504
    ds_read_b64_tr_b16 v[156:157], v8 offset:20992
    ds_read_b64_tr_b16 v[158:159], v8 offset:22016
    ds_read_b64_tr_b16 v[160:161], v8 offset:24576
    ds_read_b64_tr_b16 v[162:163], v8 offset:25600
    ds_read_b64_tr_b16 v[164:165], v8 offset:25088
    ds_read_b64_tr_b16 v[166:167], v8 offset:26112
    ds_read_b64_tr_b16 v[168:169], v8 offset:28672
    s_waitcnt lgkmcnt(8)
    ds_read_b64_tr_b16 v[170:171], v8 offset:29696
    ds_read_b64_tr_b16 v[172:173], v8 offset:29184
    ds_read_b64_tr_b16 v[174:175], v8 offset:30208
    ds_read_b64_tr_b16 v[176:177], v8 offset:32768
    ds_read_b64_tr_b16 v[178:179], v8 offset:33792
    s_waitcnt lgkmcnt(8)
    ds_read_b64_tr_b16 v[180:181], v8 offset:33280
    ds_read_b64_tr_b16 v[182:183], v8 offset:34304
    ds_read_b64_tr_b16 v[184:185], v8 offset:36864
    ds_read_b64_tr_b16 v[186:187], v8 offset:37888
    ds_read_b64_tr_b16 v[188:189], v8 offset:37376
    s_waitcnt lgkmcnt(8)
    ds_read_b64_tr_b16 v[190:191], v8 offset:38400
    ds_read_b64_tr_b16 v[192:193], v8 offset:40960
    ds_read_b64_tr_b16 v[194:195], v8 offset:41984
    ds_read_b64_tr_b16 v[196:197], v8 offset:41472
    ds_read_b64_tr_b16 v[198:199], v8 offset:42496
    s_waitcnt lgkmcnt(8)
    v_mov_b32 v216, 0x3f803f80
    v_mov_b32 v217, 0x3f803f80
    v_mov_b32 v218, 0x3f803f80
    v_mov_b32 v219, 0x3f803f80
    v_mov_b32 v252, 0xbdd2d3e8
    v_mov_b32 v253, 0xc0135761
    v_mov_b32 v254, 1.0
    v_mov_b32 v255, 1.0
    v_and_b32 v10, 3, v0
    v_and_b32 v58, 1, v0
    v_mul_u32_u24 v58, 3584, v58
    v_and_b32 v8, 2, v0
    v_lshl_add_u32 v58, v8, 13, v58
    v_bfe_u32 v8, v0, 5, 1
    v_lshl_add_u32 v58, v8, 7, v58
    v_and_b32 v8, 16, v0
    v_add_u32 v58, v8, v58
    v_and_b32 v8, 12, v0
    v_lshl_add_u32 v58, v8, 6, v58
    v_cmp_gt_u32 vcc, 8, v8
    v_mov_b32 v59, 0x7fff0000
    s_nop 0
    v_cndmask_b32 v59, v59, v58, vcc
    v_lshl_add_u32 v60, v10, 6, v11
    v_bfe_u32 v8, v0, 4, 1
    v_lshl_add_u32 v60, v8, 3, v60
    v_bfe_u32 v8, v0, 5, 1
    v_lshl_add_u32 v60, v8, 2, v60
    s_waitcnt lgkmcnt(0)
    v_mfma_f32_16x16x32_bf16 v[220:223], v[144:147], v[216:219], 0
    v_mfma_f32_16x16x32_bf16 v[220:223], v[148:151], v[216:219], v[220:223]
    v_mfma_f32_16x16x32_bf16 v[220:223], v[152:155], v[216:219], v[220:223]
    v_mfma_f32_16x16x32_bf16 v[220:223], v[156:159], v[216:219], v[220:223]
    v_mfma_f32_16x16x32_bf16 v[220:223], v[160:163], v[216:219], v[220:223]
    v_mfma_f32_16x16x32_bf16 v[220:223], v[164:167], v[216:219], v[220:223]
    v_mfma_f32_16x16x32_bf16 v[220:223], v[168:171], v[216:219], v[220:223]
    v_mfma_f32_16x16x32_bf16 v[220:223], v[172:175], v[216:219], v[220:223]
    v_mfma_f32_16x16x32_bf16 v[220:223], v[176:179], v[216:219], v[220:223]
    v_mfma_f32_16x16x32_bf16 v[220:223], v[180:183], v[216:219], v[220:223]
    v_mfma_f32_16x16x32_bf16 v[220:223], v[184:187], v[216:219], v[220:223]
    v_mfma_f32_16x16x32_bf16 v[220:223], v[188:191], v[216:219], v[220:223]
    v_mfma_f32_16x16x32_bf16 v[220:223], v[192:195], v[216:219], v[220:223]
    v_mfma_f32_16x16x32_bf16 v[220:223], v[196:199], v[216:219], v[220:223]
    s_mov_b32 s82, 131072
    s_and_b32 s73, s2, 3
    s_lshl_b32 s73, s73, 15
    s_and_b32 s74, s2, 4
    s_lshl_b32 s74, s74, 11
    s_xor_b32 s74, s74, s1
    s_add_u32 s73, s73, s74
    s_add_u32 s73, s73, 0x80000
L_pollH:
    buffer_load_dwordx4 v[200:203], v58, s[48:51], s73 offen offset:0 sc1
    buffer_load_dwordx4 v[204:207], v58, s[48:51], s73 offen offset:1024 sc1
    buffer_load_dwordx4 v[208:211], v58, s[48:51], s73 offen offset:2048 sc1
    buffer_load_dwordx4 v[212:215], v59, s[48:51], s73 offen offset:3072 sc1
    s_bcnt1_i32_b64 s15, exec
    s_cmp_gt_u32 s15, 8
    s_cbranch_scc0 L_pollH_f
    s_waitcnt vmcnt(0)
L_pollH_f:
    s_waitcnt vmcnt(28)
    s_sub_u32 s82, s82, 1
    v_max3_u32 v8, v200, v201, v202
    v_max3_u32 v9, v203, v204, v205
    v_max3_u32 v8, v8, v206, v207
    v_max3_u32 v9, v9, v208, v209
    v_max3_u32 v8, v8, v210, v211
    v_max3_u32 v9, v9, v212, v213
    v_max3_u32 v8, v8, v214, v215
    v_max_u32 v8, v8, v9
    s_cbranch_scc1 L_pollH_ok
    v_cmp_eq_u32 vcc, -1, v8
    s_mov_b64 exec, vcc
    s_cbranch_vccnz L_pollH
L_pollH_ok:
    s_mov_b64 exec, -1
    v_mfma_f32_16x16x32_bf16 v[240:243], v[216:219], v[200:203], 0
    v_mfma_f32_16x16x32_bf16 v[240:243], v[216:219], v[204:207], v[240:243]
    v_mfma_f32_16x16x32_bf16 v[240:243], v[216:219], v[208:211], v[240:243]
    v_mfma_f32_16x16x32_bf16 v[240:243], v[216:219], v[212:215], v[240:243]
    v_dot2_f32_bf16 v244, v200, v200, 0
    v_dot2_f32_bf16 v245, v204, v204, 0
    v_dot2_f32_bf16 v246, v208, v208, 0
    v_dot2_f32_bf16 v247, v212, v212, 0
    v_mfma_f32_16x16x32_bf16 v[224:227], v[144:147], v[200:203], 0
    v_dot2_f32_bf16 v244, v201, v201, v244
    v_dot2_f32_bf16 v245, v205, v205, v245
    v_dot2_f32_bf16 v246, v209, v209, v246
    v_dot2_f32_bf16 v247, v213, v213, v247
    v_mfma_f32_16x16x32_bf16 v[228:231], v[148:151], v[200:203], 0
    v_dot2_f32_bf16 v244, v202, v202, v244
    v_dot2_f32_bf16 v245, v206, v206, v245
    v_dot2_f32_bf16 v246, v210, v210, v246
    v_dot2_f32_bf16 v247, v214, v214, v247
    v_mfma_f32_16x16x32_bf16 v[232:235], v[152:155], v[200:203], 0
    v_dot2_f32_bf16 v244, v203, v203, v244
    v_dot2_f32_bf16 v245, v207, v207, v245
    v_dot2_f32_bf16 v246, v211, v211, v246
    v_dot2_f32_bf16 v247, v215, v215, v247
    v_mfma_f32_16x16x32_bf16 v[236:239], v[156:159], v[200:203], 0
    v_add_f32 v244, v244, v245
    s_nop 0
    v_add_f32 v246, v246, v247
    v_mfma_f32_16x16x32_bf16 v[224:227], v[160:163], v[204:207], v[224:227]
    v_add_f32 v244, v244, v246
    v_add_f32_dpp v240, v240, v240 row_ror:4 row_mask:0xf bank_mask:0xf
    v_mfma_f32_16x16x32_bf16 v[228:231], v[164:167], v[204:207], v[228:231]
    v_add_f32_dpp v244, v244, v244 row_ror:4 row_mask:0xf bank_mask:0xf
    v_add_f32_dpp v240, v240, v240 row_ror:8 row_mask:0xf bank_mask:0xf
    v_mfma_f32_16x16x32_bf16 v[232:235], v[168:171], v[204:207], v[232:235]
    v_add_f32_dpp v244, v244, v244 row_ror:8 row_mask:0xf bank_mask:0xf
    v_mul_f32 v240, 0x3b124925, v240
    v_mov_b32 v245, v244
    v_mfma_f32_16x16x32_bf16 v[236:239], v[172:175], v[204:207], v[236:239]
    v_mul_f32 v246, v240, v240
    v_permlane16_swap_b32 v244, v245
    v_add_f32 v244, v244, v245
    v_mov_b32 v245, v244
    v_mfma_f32_16x16x32_bf16 v[224:227], v[176:179], v[208:211], v[224:227]
    s_mov_b32 s74, 0x3b124925
    v_permlane32_swap_b32 v244, v245
    v_add_f32 v244, v244, v245
    v_mfma_f32_16x16x32_bf16 v[228:231], v[180:183], v[208:211], v[228:231]
    v_fma_f32 v244, v244, s74, -v246
    v_max_f32 v244, 0, v244
    v_mfma_f32_16x16x32_bf16 v[232:235], v[184:187], v[208:211], v[232:235]
    v_cvt_pk_bf16_f32 v245, v240, v244
    v_lshlrev_b32 v240, 16, v245
    v_and_b32 v244, 0xffff0000, v245
    v_mfma_f32_16x16x32_bf16 v[236:239], v[188:191], v[208:211], v[236:239]
    v_add_f32 v244, 0x3727c5ac, v244
    v_cvt_pk_bf16_f32 v244, v244, v244
    v_and_b32 v244, 0xffff0000, v244
    v_mfma_f32_16x16x32_bf16 v[224:227], v[192:195], v[212:215], v[224:227]
    v_sqrt_f32 v244, v244
    v_mfma_f32_16x16x32_bf16 v[228:231], v[196:199], v[212:215], v[228:231]
    v_cvt_pk_bf16_f32 v244, v244, v244
    v_and_b32 v244, 0xffff0000, v244
    v_rcp_f32 v244, v244
    v_add_f32_dpp v248, v232, v236 row_shr:4 row_mask:0xf bank_mask:0xf
    v_add_f32_dpp v249, v233, v237 row_shr:4 row_mask:0xf bank_mask:0xf
    v_add_f32_dpp v250, v234, v238 row_shr:4 row_mask:0xf bank_mask:0xf
    v_add_f32_dpp v251, v235, v239 row_shr:4 row_mask:0xf bank_mask:0xf
    s_nop 0
    v_add_f32_dpp v224, v228, v224 row_shl:4 row_mask:0xf bank_mask:0xf
    v_add_f32_dpp v225, v229, v225 row_shl:4 row_mask:0xf bank_mask:0xf
    v_add_f32_dpp v226, v230, v226 row_shl:4 row_mask:0xf bank_mask:0xf
    v_add_f32_dpp v227, v231, v227 row_shl:4 row_mask:0xf bank_mask:0xf
    v_add_f32_dpp v224, v248, v224 row_shl:12 row_mask:0xf bank_mask:0xf
    v_add_f32_dpp v225, v249, v225 row_shl:12 row_mask:0xf bank_mask:0xf
    v_add_f32_dpp v226, v250, v226 row_shl:12 row_mask:0xf bank_mask:0xf
    v_add_f32_dpp v227, v251, v227 row_shl:12 row_mask:0xf bank_mask:0xf
    v_pk_fma_f32 v[224:225], v[240:241], v[220:221], v[224:225] op_sel_hi:[0,1,1] neg_lo:[1,0,0] neg_hi:[1,0,0]
    v_pk_fma_f32 v[226:227], v[240:241], v[222:223], v[226:227] op_sel_hi:[0,1,1] neg_lo:[1,0,0] neg_hi:[1,0,0]
    v_pk_mul_f32 v[224:225], v[224:225], v[244:245] op_sel_hi:[1,0]
    v_pk_mul_f32 v[226:227], v[226:227], v[244:245] op_sel_hi:[1,0]
    v_cvt_pk_bf16_f32 v248, v224, v225
    v_cvt_pk_bf16_f32 v249, v226, v227
    s_nop 1
    v_permlane32_swap_b32 v248, v249
    v_lshlrev_b32 v224, 16, v248
    v_and_b32 v225, 0xffff0000, v248
    v_lshlrev_b32 v226, 16, v249
    v_and_b32 v227, 0xffff0000, v249
    v_pk_mul_f32 v[248:249], v[224:225], v[224:225]
    v_pk_fma_f32 v[248:249], v[248:249], v[252:253], v[252:253] op_sel:[0,0,1] op_sel_hi:[1,0,1]
    v_pk_mul_f32 v[248:249], v[248:249], v[224:225]
    v_exp_f32 v248, v248
    v_exp_f32 v249, v249
    s_nop 0
    v_pk_add_f32 v[248:249], v[248:249], v[254:255] op_sel_hi:[1,0]
    v_rcp_f32 v248, v248
    v_rcp_f32 v249, v249
    s_nop 0
    v_pk_mul_f32 v[248:249], v[248:249], v[224:225]
    v_cvt_pk_bf16_f32 v250, v248, v249
    v_lshlrev_b32 v248, 16, v250
    v_and_b32 v249, 0xffff0000, v250
    v_pk_mul_f32 v[248:249], v[248:249], v[226:227]
    v_cvt_pk_bf16_f32 v250, v248, v249
    s_mov_b32 exec_lo, 0x000f000f
    s_mov_b32 exec_hi, 0x000f000f
    ds_write_b32 v60, v250 offset:15616
    s_mov_b64 exec, -1
    s_waitcnt lgkmcnt(0)
L_ffn2:
    s_mov_b32 exec_lo, 0x11111111
    s_mov_b32 exec_hi, 0x11111111
    s_barrier
    ds_read_b128 v[64:67], v56 offset:15616
    s_lshl_b64 exec, exec, 1
    ds_read_b128 v[68:71], v56 offset:15616
    s_lshl_b64 exec, exec, 1
    ds_read_b128 v[72:75], v56 offset:15616
    s_lshl_b64 exec, exec, 1
    ds_read_b128 v[76:79], v56 offset:15616
    s_mov_b64 exec, -1
    s_waitcnt lgkmcnt(3)
    v_mfma_f32_16x16x32_bf16 v[80:83], v[64:67], v[128:131], 0
    s_waitcnt lgkmcnt(2)
    v_mfma_f32_16x16x32_bf16 v[80:83], v[68:71], v[132:135], v[80:83]
    s_waitcnt lgkmcnt(1)
    v_mfma_f32_16x16x32_bf16 v[80:83], v[72:75], v[136:139], v[80:83]
    s_waitcnt lgkmcnt(0)
    v_mfma_f32_16x16x32_bf16 v[80:83], v[76:79], v[140:143], v[80:83]
    s_nop 7
    v_bfi_b32 v80, v62, s28, v80
    v_bfi_b32 v81, v62, s29, v81
    v_bfi_b32 v82, v62, s30, v82
    v_bfi_b32 v83, v62, s31, v83
    buffer_store_dwordx4 v[80:83], v57, s[48:51], s72 offen sc1
    s_nop 1
    s_branch L_fin
L_w7tail:
    v_readfirstlane_b32 s83, v61
    s_and_b32 s83, s83, 31
    s_sub_u32 s83, s83, 12
    s_cmp_lt_u32 s83, 14
    s_nop 1
    s_cbranch_scc0 L_fin
    s_and_b32 s74, s2, 7
    s_mul_i32 s74, s74, 14
    s_add_u32 s83, s83, s74
    s_mul_i32 s69, s83, 147
    s_lshr_b32 s69, s69, 12
    s_mul_i32 s74, s69, 28
    s_sub_u32 s74, s83, s74
    s_lshl_b32 s74, s74, 6
    s_lshr_b32 s0, s69, 1
    s_lshl_b32 s0, s0, 13
    s_xor_b32 s0, s0, s1
    s_and_b32 s76, s69, 1
    s_lshl_b32 s75, s76, 18
    s_add_u32 s75, s75, s0
    s_add_u32 s72, s75, s74
    s_add_u32 s73, s72, 3584
    s_add_u32 s75, s75, 7168
    s_mul_i32 s76, s76, 1792
    s_add_u32 s76, s76, s74
    s_add_u32 s76, s76, s0
    s_add_u32 s76, s76, 0xa0000
    s_mov_b32 s44, s4
    s_mov_b32 s45, s5
    s_mov_b32 s46, 3584
    s_mov_b32 s47, 0x20000
    s_mov_b32 s64, s22
    s_mov_b32 s65, s23
    s_mov_b32 s66, 3584
    s_mov_b32 s67, 0x20000
    v_and_b32 v8, 60, v0
    v_lshlrev_b32 v57, 12, v8
    v_and_b32 v8, 56, v0
    v_lshlrev_b32 v62, 11, v8
    v_and_b32 v8, 4, v0
    v_lshl_add_u32 v62, v8, 10, v62
    v_and_b32 v8, 3, v0
    v_lshl_add_u32 v56, v8, 4, v57
    v_lshl_add_u32 v62, v8, 4, v62
    v_bfe_u32 v9, v0, 4, 1
    v_bfe_u32 v10, v0, 5, 1
    v_lshlrev_b32 v59, 3, v8
    v_lshl_add_u32 v59, v9, 2, v59
    v_lshlrev_b32 v61, 2, v59
    v_lshl_add_u32 v58, v10, 1, v61
    s_mul_i32 s77, s69, 896
    s_lshr_b32 s0, s74, 8
    s_lshl_b32 s0, s0, 7
    s_add_u32 s77, s77, s0
    s_bfe_u32 s0, s74, 0x20006
    s_lshl_b32 s0, s0, 2
    s_add_u32 s77, s77, s0
    v_and_b32 v8, 48, v0
    v_lshlrev_b32 v60, 11, v8
    v_and_b32 v8, 15, v0
    v_lshl_add_u32 v60, v8, 3, v60
    s_lshl_b32 s14, s83, 7
    s_cmp_ge_u32 s83, 56
    s_cselect_b32 s0, 9216, 0
    s_add_u32 s14, s14, s0
    s_add_u32 s14, s14, 0x80000
    s_and_b32 s15, s2, 4
    s_lshl_b32 s15, s15, 11
    s_xor_b32 s15, s15, s1
    s_xor_b32 s15, s15, 0x2000
    s_add_u32 s32, s14, s15
    s_xor_b32 s15, s15, 0x2000
    s_add_u32 s14, s14, s15
    v_cmp_gt_u32 vcc, 32, v1
    s_and_b32 s28, s28, s100
    s_and_b32 s29, s29, s100
    s_and_b32 s30, s30, s100
    s_and_b32 s31, s31, s100
    v_mov_b32 v152, s28
    v_cndmask_b32 v152, 0, v152, vcc
    v_mov_b32 v153, s29
    v_cndmask_b32 v153, 0, v153, vcc
    v_mov_b32 v154, s30
    v_cndmask_b32 v154, 0, v154, vcc
    v_mov_b32 v155, s31
    v_cndmask_b32 v155, 0, v155, vcc
    buffer_load_ushort v58, v58, s[44:47], s77 offen
    s_mov_b32 s82, 131072
    s_waitcnt vmcnt(0)
    v_lshlrev_b32 v58, 16, v58
    s_nop 1
L_pollS:
    buffer_load_dwordx4 v[80:83], v57, s[48:51], s75 offen offset:0 sc1
    buffer_load_dwordx4 v[84:87], v57, s[48:51], s75 offen offset:16 sc1
    s_sub_u32 s82, s82, 1
    s_waitcnt vmcnt(0)
    v_max3_u32 v8, v80, v81, v82
    v_max3_u32 v9, v83, v84, v85
    v_max3_u32 v8, v8, v86, v87
    v_max_u32 v8, v8, v9
    s_cbranch_scc1 L_pollS_ok
    v_cmp_eq_u32 vcc, -1, v8
    s_mov_b64 exec, vcc
    s_cbranch_vccnz L_pollS
L_pollS_ok:
    s_mov_b64 exec, -1
    v_max3_f32 v8, v80, v82, v84
    v_max_f32 v8, v8, v86
    v_mul_f32 v8, s78, v8
    v_fma_f32 v88, v80, s78, -v8
    v_fma_f32 v89, v82, s78, -v8
    v_fma_f32 v90, v84, s78, -v8
    v_fma_f32 v91, v86, s78, -v8
    v_exp_f32 v88, v88
    v_exp_f32 v89, v89
    v_exp_f32 v90, v90
    v_exp_f32 v91, v91
    v_mul_f32 v8, v88, v81
    v_fmac_f32 v8, v89, v83
    v_fmac_f32 v8, v90, v85
    v_fmac_f32 v8, v91, v87
    v_rcp_f32 v8, v8
    s_nop 0
    v_mul_f32 v88, v88, v8
    v_mul_f32 v89, v89, v8
    v_mul_f32 v90, v90, v8
    v_mul_f32 v91, v91, v8
    s_nop 1
L_pollY:
    buffer_load_dwordx4 v[64:67], v56, s[48:51], s72 offen offset:0 sc1
    buffer_load_dwordx4 v[68:71], v56, s[48:51], s72 offen offset:1792 sc1
    buffer_load_dwordx4 v[72:75], v56, s[48:51], s73 offen offset:0 sc1
    buffer_load_dwordx4 v[76:79], v56, s[48:51], s73 offen offset:1792 sc1
    s_bcnt1_i32_b64 s15, exec
    s_cmp_gt_u32 s15, 8
    s_cbranch_scc0 L_pollY_f
    s_waitcnt vmcnt(0)
L_pollY_f:
    s_waitcnt vmcnt(28)
    s_sub_u32 s82, s82, 1
    v_xor_b32 v120, s28, v64
    v_xor_b32 v121, s29, v65
    v_xor_b32 v122, s30, v66
    v_xor_b32 v123, s31, v67
    v_xor_b32 v124, s28, v68
    v_xor_b32 v125, s29, v69
    v_xor_b32 v126, s30, v70
    v_xor_b32 v127, s31, v71
    v_xor_b32 v128, s28, v72
    v_xor_b32 v129, s29, v73
    v_xor_b32 v130, s30, v74
    v_xor_b32 v131, s31, v75
    v_xor_b32 v132, s28, v76
    v_xor_b32 v133, s29, v77
    v_xor_b32 v134, s30, v78
    v_xor_b32 v135, s31, v79
    v_or3_b32 v8, v120, v121, v122
    v_or3_b32 v9, v123, v124, v125
    v_or3_b32 v8, v8, v126, v127
    v_or3_b32 v9, v9, v128, v129
    v_or3_b32 v8, v8, v130, v131
    v_or3_b32 v9, v9, v132, v133
    v_or3_b32 v8, v8, v134, v135
    v_bitop3_b32 v8, v8, v9, s100 bitop3:0xa8
    s_cbranch_scc1 L_pollY_ok
    v_cmp_ne_u32 vcc, 0, v8
    s_mov_b64 exec, vcc
    s_cbranch_vccnz L_pollY
L_pollY_ok:
    s_mov_b64 exec, -1
    v_pk_mul_f32 v[92:93], v[120:121], v[88:89] op_sel_hi:[1,0]
    v_pk_mul_f32 v[94:95], v[122:123], v[88:89] op_sel_hi:[1,0]
    v_pk_fma_f32 v[92:93], v[124:125], v[88:89], v[92:93] op_sel:[0,1,0] op_sel_hi:[1,1,1]
    v_pk_fma_f32 v[94:95], v[126:127], v[88:89], v[94:95] op_sel:[0,1,0] op_sel_hi:[1,1,1]
    v_pk_fma_f32 v[92:93], v[128:129], v[90:91], v[92:93] op_sel:[0,0,0] op_sel_hi:[1,0,1]
    v_pk_fma_f32 v[94:95], v[130:131], v[90:91], v[94:95] op_sel:[0,0,0] op_sel_hi:[1,0,1]
    v_pk_fma_f32 v[92:93], v[132:133], v[90:91], v[92:93] op_sel:[0,1,0] op_sel_hi:[1,1,1]
    v_pk_fma_f32 v[94:95], v[134:135], v[90:91], v[94:95] op_sel:[0,1,0] op_sel_hi:[1,1,1]
    s_nop 0
    v_permlane32_swap_b32 v92, v93
    v_permlane32_swap_b32 v94, v95
    v_add_f32 v92, v92, v93
    v_add_f32 v94, v94, v95
    s_nop 1
    v_permlane16_swap_b32 v92, v94
    v_add_f32 v92, v92, v94
    s_nop 1
    v_add_f32_dpp v92, v92, v92 row_ror:4 row_mask:0xf bank_mask:0xf
    s_nop 1
    v_add_f32_dpp v92, v92, v92 row_ror:8 row_mask:0xf bank_mask:0xf
    v_cvt_pk_bf16_f32 v92, v92, v92
    v_and_b32 v92, 0xffff0000, v92
    v_add_f32 v58, v58, v92
    v_mov_b32 v92, v58
    v_mov_b32 v93, v58
    s_nop 1
    v_permlane32_swap_b32 v92, v93
    v_cvt_pk_bf16_f32 v92, v92, v93
    v_min_u32 v92, -2, v92
    v_mov_b32 v93, v92
    s_nop 1
    v_permlane16_swap_b32 v92, v93
    buffer_store_dwordx2 v[92:93], v60, s[48:51], s32 offen sc1
    buffer_store_dwordx2 v[92:93], v60, s[48:51], s14 offen sc1
    v_cvt_pk_bf16_f32 v58, v58, v58
    v_and_b32 v58, 0xffff0000, v58
    s_add_u32 s74, s76, 131072
    s_add_u32 s75, s76, 262144
    s_add_u32 s72, s76, 393216
    s_mov_b64 exec, 0x1111
L_can:
    buffer_load_dword v96, v62, s[48:51], s76 offen sc1
    s_sub_u32 s82, s82, 1
    s_waitcnt vmcnt(0)
    s_cbranch_scc1 L_can_ok
    v_xor_b32 v96, s28, v96
    v_and_b32 v96, s100, v96
    v_cmp_ne_u32 vcc, 0, v96
    s_cmp_eq_u64 vcc, exec
    s_cbranch_scc1 L_can
L_can_ok:
    s_mov_b64 exec, -1
    s_nop 1
L_pollP:
    buffer_load_dwordx4 v[96:99], v62, s[48:51], s76 offen sc1
    buffer_load_dwordx4 v[100:103], v62, s[48:51], s74 offen sc1
    buffer_load_dwordx4 v[104:107], v62, s[48:51], s75 offen sc1
    buffer_load_dwordx4 v[108:111], v62, s[48:51], s72 offen sc1
    s_bcnt1_i32_b64 s15, exec
    s_cmp_gt_u32 s15, 16
    s_cbranch_scc0 L_pollP_f
    s_waitcnt vmcnt(0)
L_pollP_f:
    s_waitcnt vmcnt(28)
    s_sub_u32 s82, s82, 1
    v_xor_b32 v136, s28, v96
    v_xor_b32 v137, s29, v97
    v_xor_b32 v138, s30, v98
    v_xor_b32 v139, s31, v99
    v_xor_b32 v140, s28, v100
    v_xor_b32 v141, s29, v101
    v_xor_b32 v142, s30, v102
    v_xor_b32 v143, s31, v103
    v_xor_b32 v144, s28, v104
    v_xor_b32 v145, s29, v105
    v_xor_b32 v146, s30, v106
    v_xor_b32 v147, s31, v107
    v_xor_b32 v148, v152, v108
    v_xor_b32 v149, v153, v109
    v_xor_b32 v150, v154, v110
    v_xor_b32 v151, v155, v111
    v_or3_b32 v8, v136, v137, v138
    v_or3_b32 v9, v139, v140, v141
    v_or3_b32 v8, v8, v142, v143
    v_or3_b32 v9, v9, v144, v145
    v_or3_b32 v8, v8, v146, v147
    v_or3_b32 v9, v9, v148, v149
    v_or3_b32 v8, v8, v150, v151
    v_bitop3_b32 v8, v8, v9, s100 bitop3:0xa8
    s_cbranch_scc1 L_pollP_ok
    v_cmp_ne_u32 vcc, 0, v8
    s_mov_b64 exec, vcc
    s_cbranch_vccnz L_pollP
L_pollP_ok:
    s_mov_b64 exec, -1
    v_pk_add_f32 v[112:113], v[136:137], v[140:141]
    v_pk_add_f32 v[114:115], v[138:139], v[142:143]
    v_pk_add_f32 v[116:117], v[144:145], v[148:149]
    v_pk_add_f32 v[118:119], v[146:147], v[150:151]
    v_pk_add_f32 v[112:113], v[112:113], v[116:117]
    v_pk_add_f32 v[114:115], v[114:115], v[118:119]
    s_nop 0
    v_permlane32_swap_b32 v112, v113
    v_permlane32_swap_b32 v114, v115
    v_add_f32 v112, v112, v113
    v_add_f32 v114, v114, v115
    s_nop 1
    v_permlane16_swap_b32 v112, v114
    v_add_f32 v112, v112, v114
    s_nop 1
    v_add_f32_dpp v112, v112, v112 row_ror:4 row_mask:0xf bank_mask:0xf
    s_nop 1
    v_add_f32_dpp v112, v112, v112 row_ror:8 row_mask:0xf bank_mask:0xf
    v_cvt_pk_bf16_f32 v112, v112, v112
    v_and_b32 v112, 0xffff0000, v112
    v_add_f32 v112, v58, v112
    v_mov_b32 v113, v112
    s_nop 1
    v_permlane32_swap_b32 v112, v113
    v_cvt_pk_bf16_f32 v112, v112, v113
    s_mov_b32 exec_lo, 0x000f000f
    s_mov_b32 exec_hi, 0
    buffer_store_dword v112, v61, s[64:67], s77 offen
    s_mov_b64 exec, -1
L_fin:
L_end:
    s_endpgm
.p2align 8
L_codeend:
    s_endpgm
    s_endpgm
    s_endpgm
    s_endpgm
    s_endpgm
    s_endpgm
    s_endpgm
    s_endpgm
    s_endpgm
    s_endpgm
    s_endpgm
    s_endpgm
    s_endpgm
    s_endpgm
    s_endpgm
    s_endpgm
    s_endpgm
    s_endpgm
    s_endpgm
    s_endpgm
    s_endpgm
    s_endpgm
    s_endpgm
    s_endpgm
    s_endpgm
    s_endpgm
    s_endpgm
    s_endpgm
    s_endpgm
    s_endpgm
    s_endpgm
    s_endpgm
    s_endpgm
    s_endpgm
    s_endpgm
    s_endpgm
    s_endpgm
    s_endpgm
    s_endpgm
    s_endpgm
    s_endpgm
    s_endpgm
    s_endpgm
    s_endpgm
    s_endpgm
    s_endpgm
    s_endpgm
    s_endpgm
    s_endpgm
    s_endpgm
    s_endpgm
    s_endpgm
    s_endpgm
    s_endpgm
    s_endpgm
    s_endpgm
    s_endpgm
    s_endpgm
    s_endpgm
    s_endpgm
    s_endpgm
    s_endpgm
    s_endpgm
    s_endpgm
    s_endpgm
    s_endpgm
    s_endpgm
    s_endpgm
    s_endpgm
    s_endpgm
    s_endpgm
    s_endpgm
    s_endpgm
    s_endpgm
    s_endpgm
    s_endpgm
    s_endpgm
    s_endpgm
    s_endpgm
    s_endpgm
    s_endpgm
    s_endpgm
    s_endpgm
    s_endpgm
    s_endpgm
    s_endpgm
    s_endpgm
    s_endpgm
    s_endpgm
    s_endpgm
    s_endpgm
    s_endpgm
    s_endpgm
    s_endpgm
    s_endpgm
    s_endpgm
    s_endpgm
    s_endpgm
    s_endpgm
    s_endpgm
    s_endpgm
    s_endpgm
    s_endpgm
    s_endpgm
    s_endpgm
    s_endpgm
    s_endpgm
    s_endpgm
    s_endpgm
    s_endpgm
    s_endpgm
    s_endpgm
    s_endpgm
    s_endpgm
    s_endpgm
    s_endpgm
    s_endpgm
    s_endpgm
    s_endpgm
    s_endpgm
    s_endpgm
    s_endpgm
    s_endpgm
    s_endpgm
    s_endpgm
    s_endpgm
    s_endpgm
    s_endpgm
    s_endpgm
    s_endpgm
    s_endpgm
    s_endpgm
    s_endpgm
    s_endpgm
    s_endpgm
    s_endpgm
    s_endpgm
    s_endpgm
    s_endpgm
    s_endpgm
    s_endpgm
    s_endpgm
    s_endpgm
    s_endpgm
    s_endpgm
    s_endpgm
    s_endpgm
    s_endpgm
    s_endpgm
    s_endpgm
    s_endpgm
    s_endpgm
    s_endpgm
    s_endpgm
    s_endpgm
    s_endpgm
    s_endpgm
    s_endpgm
    s_endpgm
    s_endpgm
    s_endpgm
    s_endpgm
    s_endpgm
    s_endpgm
    s_endpgm
    s_endpgm
    s_endpgm
    s_endpgm
    s_endpgm
    s_endpgm
    s_endpgm
    s_endpgm
    s_endpgm
    s_endpgm
    s_endpgm
    s_endpgm
    s_endpgm
    s_endpgm
    s_endpgm
    s_endpgm
    s_endpgm
    s_endpgm
    s_endpgm
    s_endpgm
    s_endpgm
    s_endpgm
    s_endpgm
    s_endpgm
    s_endpgm
    s_endpgm
    s_endpgm
    s_endpgm
    s_endpgm
    s_endpgm
    s_endpgm
    s_endpgm
    s_endpgm
    s_endpgm
    s_endpgm
    s_endpgm
    s_endpgm
    s_endpgm
    s_endpgm
    s_endpgm
    s_endpgm
    s_endpgm
    s_endpgm
    s_endpgm
    s_endpgm
    s_endpgm
    s_endpgm
    s_endpgm
    s_endpgm
    s_endpgm
    s_endpgm
    s_endpgm
    s_endpgm
    s_endpgm
    s_endpgm
    s_endpgm
    s_endpgm
    s_endpgm
    s_endpgm
    s_endpgm
    s_endpgm
    s_endpgm
    s_endpgm
    s_endpgm
    s_endpgm
    s_endpgm
    s_endpgm
    s_endpgm
    s_endpgm
    s_endpgm
    s_endpgm
    s_endpgm
    s_endpgm
    s_endpgm
    s_endpgm
    s_endpgm
    s_endpgm
    s_endpgm
    s_endpgm
    s_endpgm
    s_endpgm
    s_endpgm
    s_endpgm
    s_endpgm
    s_endpgm
    s_endpgm
    s_endpgm
    s_endpgm
    s_endpgm
    s_endpgm
    s_endpgm
    s_endpgm
.section .rodata,"a"
.p2align 6
.amdhsa_kernel sequential_preLN__mha_block_cached__glu_gated_geglu__decode_kernel
  .amdhsa_next_free_vgpr 256
  .amdhsa_next_free_sgpr 102
  .amdhsa_accum_offset 256
  .amdhsa_group_segment_fixed_size 0
  .amdhsa_kernarg_size 96
  .amdhsa_user_sgpr_count 2
  .amdhsa_user_sgpr_kernarg_segment_ptr 1
  .amdhsa_system_sgpr_workgroup_id_x 1
.end_amdhsa_kernel
```
